```python
import torch

def _softmax(x, axis=-1):
    return torch.softmax(x, dim=axis)

def _gelu(x):
    return torch.nn.functional.gelu(x, approximate='tanh')

def _silu(x):
    return torch.nn.functional.silu(x)

def _sigmoid(x):
    return torch.sigmoid(x)

def _layernorm(x, axis=-1, eps=1e-05):
    m = x.mean(dim=axis, keepdim=True)
    v = x.var(dim=axis, keepdim=True, unbiased=False)
    return (x - m) / torch.sqrt(v + eps)

def _scatter_add(tgt, idx, src, axis=0):
    return tgt.clone().index_add_(axis, idx, src)

def _segment_sum(src, seg, n):
    out = torch.zeros((n,) + src.shape[1:], dtype=src.dtype)
    return out.index_add_(0, seg, src)

def _pad(x, pw):
    flat = tuple((v for pair in reversed(pw) for v in pair))
    return torch.nn.functional.pad(x, flat)
kernel_name = 'adaLN_cond__gqa_block_cached__glu_gated_geglu__decode'

def setup_inputs():

    _w = lambda a: (lambda t: t.to(torch.bfloat16) if t.is_floating_point() else t)(torch.as_tensor(a))

    def _A_setup():
        B, Sq, D = (2, 1, 512)
        Hq, Hkv, Sk, Dh = (32, 8, 32768, 128)
        assert Hq % Hkv == 0, (Hq, Hkv)
        return {'x': _w((lambda *s: torch.randn(*s, dtype=torch.bfloat16) * 0.05)(B, Sq, D)), 'k_cache': _w((lambda *s: torch.randn(*s, dtype=torch.bfloat16) * 0.8)(B, Hkv, Sk, Dh)), 'v_cache': _w((lambda *s: torch.randn(*s, dtype=torch.bfloat16) * 3.2)(B, Hkv, Sk, Dh)), 'wq': _w((lambda *s: torch.randn(*s, dtype=torch.bfloat16) * 0.8)(D, Hq * Dh) * D ** (-0.5)), 'wo': _w((lambda *s: torch.randn(*s, dtype=torch.bfloat16) * 3.2)(Hq * Dh, D) * (Hq * Dh) ** (-0.5))}
    _A_in = _A_setup()

    def _B_setup():
        B, S, Dm, Df = (2, 1, 512, 1792)
        return {'x': _w((lambda *s: torch.randn(*s, dtype=torch.bfloat16) * 0.05)(B, S, Dm)), 'w_gate': _w((lambda *s: torch.randn(*s, dtype=torch.bfloat16) * 3.2)(Dm, Df) * Dm ** (-0.5)), 'w_up': _w((lambda *s: torch.randn(*s, dtype=torch.bfloat16) * 3.2)(Dm, Df) * Dm ** (-0.5)), 'w_down': _w((lambda *s: torch.randn(*s, dtype=torch.bfloat16) * 3.2)(Df, Dm) * Df ** (-0.5))}
    _B_in = _B_setup()
    return {'A_x': _A_in['x'], 'A_k_cache': _A_in['k_cache'], 'A_v_cache': _A_in['v_cache'], 'A_wq': _A_in['wq'], 'A_wo': _A_in['wo'], 'B_x': _B_in['x'], 'B_w_gate': _B_in['w_gate'], 'B_w_up': _B_in['w_up'], 'B_w_down': _B_in['w_down'], 'c': _w((lambda *s: torch.randn(*s, dtype=torch.bfloat16) * 0.4)(2, 512) * 8.0), 'w_mod': _w((lambda *s: torch.randn(*s, dtype=torch.bfloat16) * 0.4)(512, 6 * 512) * 512 ** (-0.5) * 8.0)}

def reference(A_x, A_k_cache, A_v_cache, A_wq, A_wo, B_x, B_w_gate, B_w_up, B_w_down, c, w_mod):

    def _A_ref(x, k_cache, v_cache, wq, wo):
        B, Sq, D = x.shape
        Hq, Dh = (32, 128)
        Hkv = k_cache.shape[1]
        rep = Hq // Hkv
        q = (lambda x, *d: x.permute(*d))((x @ wq).reshape(B, Sq, Hq, Dh), 0, 2, 1, 3)
        k = (lambda x, n, axis: torch.repeat_interleave(x, n, dim=axis))(k_cache, rep, axis=1)
        v = (lambda x, n, axis: torch.repeat_interleave(x, n, dim=axis))(v_cache, rep, axis=1)
        scores = torch.einsum('bhqd,bhkd->bhqk', q, k) * Dh ** (-0.5)
        p = _softmax(scores, axis=-1)
        o = torch.einsum('bhqk,bhkd->bhqd', p, v)
        return (lambda x, *d: x.permute(*d))(o, 0, 2, 1, 3).reshape(B, Sq, Hq * Dh) @ wo

    def _B_ref(x, w_gate, w_up, w_down):
        g = torch.einsum('bsd,df->bsf', x, w_gate)
        u = torch.einsum('bsd,df->bsf', x, w_up)
        h = _gelu(g) * u
        return torch.einsum('bsf,fd->bsd', h, w_down)
    x = A_x
    mod = (_silu(c) @ w_mod).reshape(c.shape[0], 6, 1, -1)
    sa, ca, ga, sb, cb, gb = (mod[:, 0].clone(), mod[:, 1].clone(), mod[:, 2].clone(), mod[:, 3].clone(), mod[:, 4].clone(), mod[:, 5].clone())
    h = _layernorm(x, axis=-1) * (1 + ca) + sa
    x = x + ga * _A_ref(h, A_k_cache, A_v_cache, A_wq, A_wo)
    h = _layernorm(x, axis=-1) * (1 + cb) + sb
    x = x + gb * _B_ref(h, B_w_gate, B_w_up, B_w_down)
    return x
```

```asm
; @launch grid=(256,1,1) block=(512,1,1) lds=154112
.amdgcn_target "amdgcn-amd-amdhsa--gfx950"
.text
.globl adaLN_cond__gqa_block_cached__glu_gated_geglu__decode_kernel
.p2align 8
.type adaLN_cond__gqa_block_cached__glu_gated_geglu__decode_kernel,@function
adaLN_cond__gqa_block_cached__glu_gated_geglu__decode_kernel:
    s_cmp_ge_u32 s2, 256
    s_cbranch_scc1 L_END
    s_load_dwordx4 s[4:7], s[0:1], 8
    s_load_dwordx2 s[8:9], s[0:1], 104
    s_load_dwordx4 s[56:59], s[0:1], 80
    s_load_dwordx4 s[52:55], s[0:1], 64
    s_load_dwordx4 s[44:47], s[0:1], 24
    s_load_dwordx4 s[48:51], s[0:1], 48
    s_load_dwordx2 s[40:41], s[0:1], 0
    v_lshrrev_b32 v1, 6, v0
    v_and_b32 v0, 63, v0
    v_readfirstlane_b32 s3, v1
    s_mov_b32 s76, s2
    s_and_b32 s11, s2, 7
    s_lshr_b32 s12, s2, 3
    s_lshl_b32 s10, s11, 1
    s_add_u32 s10, s10, s12
    s_and_b32 s10, s10, 15
    s_lshr_b32 s12, s2, 7
    s_lshl_b32 s12, s12, 3
    s_add_u32 s11, s11, s12
    s_lshr_b32 s12, s10, 3
    s_lshl_b32 s2, s10, 4
    s_add_u32 s2, s2, s11
    s_mov_b32 s22, 0x05040100
    s_mov_b32 s23, 0x07060302
    s_mov_b32 s19, 0
    s_mov_b32 s17, 0xffffff00
    s_mov_b32 s35, 0x3fb8aa3b
    v_mov_b32 v4, 0
    v_lshlrev_b32 v5, 4, v0
    s_cmp_ge_u32 s3, 4
    s_cbranch_scc1 L_HELP
    v_and_b32 v2, 3, v0
    v_lshlrev_b32 v2, 10, v2
    v_and_b32 v3, 4, v0
    v_lshl_add_u32 v2, v3, 6, v2
    v_and_b32 v3, 8, v0
    v_lshl_add_u32 v2, v3, 12, v2
    v_and_or_b32 v1, v0, 48, v2
    v_and_b32 v69, 0x1f0, v5
    v_and_b32 v3, 32, v0
    v_lshl_add_u32 v69, v3, 10, v69
    s_lshl_b32 s13, s11, 2
    s_add_u32 s13, s13, s3
    s_lshl_b32 s14, s10, 23
    s_lshl_b32 s15, s13, 12
    s_lshr_b32 s16, s76, 6
    s_lshl_b32 s16, s16, 3
    s_lshr_b32 s16, 197122, s16
    s_and_b32 s16, s16, 0xff
    s_lshl_b32 s16, s16, 18
    s_add_u32 s15, s15, s16
    s_waitcnt lgkmcnt(0)
    s_add_u32 s4, s4, s14
    s_addc_u32 s5, s5, 0
    s_add_u32 s6, s6, s14
    s_addc_u32 s7, s7, 0
    s_lshr_b32 s14, s15, 6
    s_and_b32 s14, s14, 0x200
    s_and_b32 s15, s15, 0xffff7fff
    s_or_b32 s15, s15, s14
    s_lshr_b32 s16, s76, 6
    s_cmp_eq_u32 s16, 2
    s_cselect_b32 s16, 1, 0
    s_cmp_lt_u32 s76, 16
    s_cselect_b32 s16, 1, s16
    s_mov_b32 s93, s16
    s_lshr_b32 s14, s76, 6
    s_sub_u32 s14, s14, 1
    s_cmp_lt_u32 s14, 2
    s_cselect_b32 s91, 1, 0
    s_and_b32 s14, s76, 0xf4
    s_cmp_eq_u32 s14, 0xb4
    s_cselect_b32 s91, 0, s91
    s_lshr_b32 s14, s76, 6
    s_cmp_eq_u32 s14, 1
    s_cselect_b32 s91, 0, s91
    s_cmp_eq_u32 s16, 0
    s_cbranch_scc0 L_HOLD
L_NOHOLD:
    s_lshr_b32 s19, s15, 8
    s_and_b32 s19, s19, 0x3000
    s_xor_b32 s19, s19, s15
    s_lshr_b32 s81, s15, 5
    s_and_b32 s81, s81, 0x4000
    s_xor_b32 s19, s19, s81
    s_lshr_b32 s81, s15, 12
    s_and_b32 s81, s81, 0x200
    s_xor_b32 s19, s19, s81
    s_add_u32 s24, s4, s19
    s_addc_u32 s25, s5, 0
    global_load_dwordx4 v[96:99], v1, s[24:25] offset:0 nt
    global_load_dwordx4 v[100:103], v1, s[24:25] offset:64 nt
    global_load_dwordx4 v[104:107], v1, s[24:25] offset:128 nt
    global_load_dwordx4 v[108:111], v1, s[24:25] offset:192 nt
    s_add_u32 s26, s6, s19
    s_addc_u32 s27, s7, 0
    global_load_dwordx4 v[112:115], v69, s[26:27] offset:0 nt
    global_load_dwordx4 v[116:119], v69, s[26:27] offset:1024 nt
    global_load_dwordx4 v[120:123], v69, s[26:27] offset:2048 nt
    global_load_dwordx4 v[124:127], v69, s[26:27] offset:3072 nt
    s_cmp_eq_u32 s93, 1
    s_cbranch_scc1 L_NOB0
    s_barrier
L_NOB0:
    v_mov_b32 v8, 0
    v_mov_b32 v9, 0
    v_mov_b32 v10, 0
    v_mov_b32 v11, 0
    v_mov_b32 v12, 0
    v_mov_b32 v13, 0
    v_mov_b32 v14, 0
    v_mov_b32 v15, 0
    v_mov_b32 v16, 0
    v_mov_b32 v17, 0
    v_mov_b32 v18, 0
    v_mov_b32 v19, 0
    v_mov_b32 v20, 0
    v_mov_b32 v21, 0
    v_mov_b32 v22, 0
    v_mov_b32 v23, 0
    v_mov_b32 v24, 0
    v_mov_b32 v25, 0
    v_mov_b32 v26, 0
    v_mov_b32 v27, 0
    v_mov_b32 v28, 0
    v_mov_b32 v29, 0
    v_mov_b32 v30, 0
    v_mov_b32 v31, 0
    v_mov_b32 v32, 0
    v_mov_b32 v33, 0
    v_mov_b32 v34, 0
    v_mov_b32 v35, 0
    v_mov_b32 v36, 0
    v_mov_b32 v37, 0
    v_mov_b32 v38, 0
    v_mov_b32 v39, 0
    v_mov_b32 v40, 0
    v_mov_b32 v41, 0
    v_mov_b32 v42, 0
    v_mov_b32 v43, 0
    v_mov_b32 v44, 0
    v_mov_b32 v45, 0
    v_mov_b32 v46, 0
    v_mov_b32 v47, 0
    v_mov_b32 v48, 0
    v_mov_b32 v49, 0
    v_mov_b32 v50, 0
    v_mov_b32 v51, 0
    v_mov_b32 v52, 0
    v_mov_b32 v53, 0
    v_mov_b32 v54, 0
    v_mov_b32 v55, 0
    v_mov_b32 v72, 0xff800000
    v_mov_b32 v73, 0xff800000
    v_mov_b32 v74, 0
    s_and_b32 s86, s13, 15
    s_lshl_b32 s16, s10, 5
    s_add_u32 s16, s16, s86
    s_lshl_b32 s16, s16, 7
    s_add_u32 s16, s16, 393216
    s_add_u32 s28, s8, s16
    s_addc_u32 s29, s9, 0
    s_lshl_b32 s16, s10, 5
    s_add_u32 s16, s16, s3
    s_lshl_b32 s16, s16, 7
    s_add_u32 s16, s16, 395264
    s_add_u32 s30, s8, s16
    s_addc_u32 s31, s9, 0
    s_mov_b32 s83, 0
    s_lshr_b32 s16, s76, 6
    s_lshl_b32 s16, s16, 3
    s_lshr_b32 s87, 505093148, s16
    s_and_b32 s87, s87, 0xff
    s_sub_u32 s88, s87, 1
    s_mov_b32 s34, 0x3db504f3
    s_mul_i32 s39, s3, 32768
    s_add_u32 s39, s39, 13824
    s_lshl_b32 s16, s3, 13
    s_add_u32 s16, s16, 121344
    s_cmp_eq_u32 s91, 1
    s_cselect_b32 s39, s16, s39
    s_add_u32 s15, s15, 262144
    s_waitcnt vmcnt(4)
    s_lshr_b32 s19, s15, 8
    s_and_b32 s19, s19, 0x3000
    s_xor_b32 s19, s19, s15
    s_lshr_b32 s81, s15, 5
    s_and_b32 s81, s81, 0x4000
    s_xor_b32 s19, s19, s81
    s_lshr_b32 s81, s15, 12
    s_and_b32 s81, s81, 0x200
    s_xor_b32 s19, s19, s81
    s_add_u32 s24, s4, s19
    s_addc_u32 s25, s5, 0
    global_load_dwordx4 v[160:163], v1, s[24:25] offset:0 nt
    global_load_dwordx4 v[164:167], v1, s[24:25] offset:64 nt
    global_load_dwordx4 v[168:171], v1, s[24:25] offset:128 nt
    global_load_dwordx4 v[172:175], v1, s[24:25] offset:192 nt
    s_waitcnt vmcnt(4)
    s_add_u32 s26, s6, s19
    s_addc_u32 s27, s7, 0
    global_load_dwordx4 v[176:179], v69, s[26:27] offset:0 nt
    global_load_dwordx4 v[180:183], v69, s[26:27] offset:1024 nt
    global_load_dwordx4 v[184:187], v69, s[26:27] offset:2048 nt
    global_load_dwordx4 v[188:191], v69, s[26:27] offset:3072 nt
    s_add_u32 s15, s15, 262144
    s_waitcnt vmcnt(4)
    s_lshr_b32 s19, s15, 8
    s_and_b32 s19, s19, 0x3000
    s_xor_b32 s19, s19, s15
    s_lshr_b32 s81, s15, 5
    s_and_b32 s81, s81, 0x4000
    s_xor_b32 s19, s19, s81
    s_lshr_b32 s81, s15, 12
    s_and_b32 s81, s81, 0x200
    s_xor_b32 s19, s19, s81
    s_add_u32 s24, s4, s19
    s_addc_u32 s25, s5, 0
    global_load_dwordx4 v[192:195], v1, s[24:25] offset:0 nt
    global_load_dwordx4 v[196:199], v1, s[24:25] offset:64 nt
    global_load_dwordx4 v[200:203], v1, s[24:25] offset:128 nt
    global_load_dwordx4 v[204:207], v1, s[24:25] offset:192 nt
    s_waitcnt vmcnt(4)
    s_add_u32 s26, s6, s19
    s_addc_u32 s27, s7, 0
    global_load_dwordx4 v[208:211], v69, s[26:27] offset:0 nt
    global_load_dwordx4 v[212:215], v69, s[26:27] offset:1024 nt
    global_load_dwordx4 v[216:219], v69, s[26:27] offset:2048 nt
    global_load_dwordx4 v[220:223], v69, s[26:27] offset:3072 nt
    s_cmp_eq_u32 s91, 1
    s_cbranch_scc1 L_NOS2
    s_add_u32 s15, s15, 262144
    s_waitcnt vmcnt(4)
    s_lshr_b32 s19, s15, 8
    s_and_b32 s19, s19, 0x3000
    s_xor_b32 s19, s19, s15
    s_lshr_b32 s81, s15, 5
    s_and_b32 s81, s81, 0x4000
    s_xor_b32 s19, s19, s81
    s_lshr_b32 s81, s15, 12
    s_and_b32 s81, s81, 0x200
    s_xor_b32 s19, s19, s81
    s_add_u32 s24, s4, s19
    s_addc_u32 s25, s5, 0
    global_load_dwordx4 v[224:227], v1, s[24:25] offset:0 nt
    global_load_dwordx4 v[228:231], v1, s[24:25] offset:64 nt
    global_load_dwordx4 v[232:235], v1, s[24:25] offset:128 nt
    global_load_dwordx4 v[236:239], v1, s[24:25] offset:192 nt
    s_waitcnt vmcnt(4)
    s_add_u32 s26, s6, s19
    s_addc_u32 s27, s7, 0
    global_load_dwordx4 v[240:243], v69, s[26:27] offset:0 nt
    global_load_dwordx4 v[244:247], v69, s[26:27] offset:1024 nt
    global_load_dwordx4 v[248:251], v69, s[26:27] offset:2048 nt
    global_load_dwordx4 v[252:255], v69, s[26:27] offset:3072 nt
L_NOS2:
    s_add_u32 s15, s15, 262144
    s_waitcnt vmcnt(4)
    s_lshr_b32 s19, s15, 8
    s_and_b32 s19, s19, 0x3000
    s_xor_b32 s19, s19, s15
    s_lshr_b32 s81, s15, 5
    s_and_b32 s81, s81, 0x4000
    s_xor_b32 s19, s19, s81
    s_lshr_b32 s81, s15, 12
    s_and_b32 s81, s81, 0x200
    s_xor_b32 s19, s19, s81
    s_add_u32 s24, s4, s19
    s_addc_u32 s25, s5, 0
    s_add_u32 m0, s39, 0
    s_nop 0
    global_load_lds_dwordx4 v1, s[24:25] offset:0 nt
    s_add_u32 m0, s39, 960
    s_nop 0
    global_load_lds_dwordx4 v1, s[24:25] offset:64 nt
    s_add_u32 m0, s39, 1920
    s_nop 0
    global_load_lds_dwordx4 v1, s[24:25] offset:128 nt
    s_add_u32 m0, s39, 2880
    s_nop 0
    global_load_lds_dwordx4 v1, s[24:25] offset:192 nt
    s_waitcnt vmcnt(4)
    s_add_u32 s26, s6, s19
    s_addc_u32 s27, s7, 0
    s_add_u32 m0, s39, 4096
    s_nop 0
    global_load_lds_dwordx4 v69, s[26:27] offset:0 nt
    global_load_lds_dwordx4 v69, s[26:27] offset:1024 nt
    global_load_lds_dwordx4 v69, s[26:27] offset:2048 nt
    global_load_lds_dwordx4 v69, s[26:27] offset:3072 nt
    s_cmp_eq_u32 s91, 1
    s_cbranch_scc1 L_NOLDS
    s_add_u32 s15, s15, 262144
    s_waitcnt vmcnt(4)
    s_lshr_b32 s19, s15, 8
    s_and_b32 s19, s19, 0x3000
    s_xor_b32 s19, s19, s15
    s_lshr_b32 s81, s15, 5
    s_and_b32 s81, s81, 0x4000
    s_xor_b32 s19, s19, s81
    s_lshr_b32 s81, s15, 12
    s_and_b32 s81, s81, 0x200
    s_xor_b32 s19, s19, s81
    s_add_u32 s24, s4, s19
    s_addc_u32 s25, s5, 0
    s_add_u32 m0, s39, 8192
    s_nop 0
    global_load_lds_dwordx4 v1, s[24:25] offset:0 nt
    s_add_u32 m0, s39, 9152
    s_nop 0
    global_load_lds_dwordx4 v1, s[24:25] offset:64 nt
    s_add_u32 m0, s39, 10112
    s_nop 0
    global_load_lds_dwordx4 v1, s[24:25] offset:128 nt
    s_add_u32 m0, s39, 11072
    s_nop 0
    global_load_lds_dwordx4 v1, s[24:25] offset:192 nt
    s_waitcnt vmcnt(4)
    s_add_u32 s26, s6, s19
    s_addc_u32 s27, s7, 0
    s_add_u32 m0, s39, 12288
    s_nop 0
    global_load_lds_dwordx4 v69, s[26:27] offset:0 nt
    global_load_lds_dwordx4 v69, s[26:27] offset:1024 nt
    global_load_lds_dwordx4 v69, s[26:27] offset:2048 nt
    global_load_lds_dwordx4 v69, s[26:27] offset:3072 nt
    s_add_u32 s15, s15, 262144
    s_waitcnt vmcnt(4)
    s_lshr_b32 s19, s15, 8
    s_and_b32 s19, s19, 0x3000
    s_xor_b32 s19, s19, s15
    s_lshr_b32 s81, s15, 5
    s_and_b32 s81, s81, 0x4000
    s_xor_b32 s19, s19, s81
    s_lshr_b32 s81, s15, 12
    s_and_b32 s81, s81, 0x200
    s_xor_b32 s19, s19, s81
    s_add_u32 s24, s4, s19
    s_addc_u32 s25, s5, 0
    s_add_u32 m0, s39, 16384
    s_nop 0
    global_load_lds_dwordx4 v1, s[24:25] offset:0 nt
    s_add_u32 m0, s39, 17344
    s_nop 0
    global_load_lds_dwordx4 v1, s[24:25] offset:64 nt
    s_add_u32 m0, s39, 18304
    s_nop 0
    global_load_lds_dwordx4 v1, s[24:25] offset:128 nt
    s_add_u32 m0, s39, 19264
    s_nop 0
    global_load_lds_dwordx4 v1, s[24:25] offset:192 nt
    s_waitcnt vmcnt(4)
    s_add_u32 s26, s6, s19
    s_addc_u32 s27, s7, 0
    s_add_u32 m0, s39, 20480
    s_nop 0
    global_load_lds_dwordx4 v69, s[26:27] offset:0 nt
    global_load_lds_dwordx4 v69, s[26:27] offset:1024 nt
    global_load_lds_dwordx4 v69, s[26:27] offset:2048 nt
    global_load_lds_dwordx4 v69, s[26:27] offset:3072 nt
    s_add_u32 s15, s15, 262144
    s_waitcnt vmcnt(4)
    s_lshr_b32 s19, s15, 8
    s_and_b32 s19, s19, 0x3000
    s_xor_b32 s19, s19, s15
    s_lshr_b32 s81, s15, 5
    s_and_b32 s81, s81, 0x4000
    s_xor_b32 s19, s19, s81
    s_lshr_b32 s81, s15, 12
    s_and_b32 s81, s81, 0x200
    s_xor_b32 s19, s19, s81
    s_add_u32 s24, s4, s19
    s_addc_u32 s25, s5, 0
    s_add_u32 m0, s39, 24576
    s_nop 0
    global_load_lds_dwordx4 v1, s[24:25] offset:0 nt
    s_add_u32 m0, s39, 25536
    s_nop 0
    global_load_lds_dwordx4 v1, s[24:25] offset:64 nt
    s_add_u32 m0, s39, 26496
    s_nop 0
    global_load_lds_dwordx4 v1, s[24:25] offset:128 nt
    s_add_u32 m0, s39, 27456
    s_nop 0
    global_load_lds_dwordx4 v1, s[24:25] offset:192 nt
    s_waitcnt vmcnt(4)
    s_add_u32 s26, s6, s19
    s_addc_u32 s27, s7, 0
    s_add_u32 m0, s39, 28672
    s_nop 0
    global_load_lds_dwordx4 v69, s[26:27] offset:0 nt
    global_load_lds_dwordx4 v69, s[26:27] offset:1024 nt
    global_load_lds_dwordx4 v69, s[26:27] offset:2048 nt
    global_load_lds_dwordx4 v69, s[26:27] offset:3072 nt
L_NOLDS:
    s_add_u32 s15, s15, 262144
    s_waitcnt vmcnt(4)
    s_lshr_b32 s19, s15, 8
    s_and_b32 s19, s19, 0x3000
    s_xor_b32 s19, s19, s15
    s_lshr_b32 s81, s15, 5
    s_and_b32 s81, s81, 0x4000
    s_xor_b32 s19, s19, s81
    s_lshr_b32 s81, s15, 12
    s_and_b32 s81, s81, 0x200
    s_xor_b32 s19, s19, s81
    s_add_u32 s24, s4, s19
    s_addc_u32 s25, s5, 0
    global_load_dwordx4 v[128:131], v1, s[24:25] offset:0 nt
    global_load_dwordx4 v[132:135], v1, s[24:25] offset:64 nt
    global_load_dwordx4 v[136:139], v1, s[24:25] offset:128 nt
    global_load_dwordx4 v[140:143], v1, s[24:25] offset:192 nt
    s_waitcnt vmcnt(4)
    s_add_u32 s26, s6, s19
    s_addc_u32 s27, s7, 0
    global_load_dwordx4 v[144:147], v69, s[26:27] offset:0 nt
    global_load_dwordx4 v[148:151], v69, s[26:27] offset:1024 nt
    global_load_dwordx4 v[152:155], v69, s[26:27] offset:2048 nt
    global_load_dwordx4 v[156:159], v69, s[26:27] offset:3072 nt
    s_mov_b32 s21, 1600000
    v_mov_b32 v64, 0
FWQF_1:
    ds_read_b32 v60, v64 offset:1088
    s_waitcnt lgkmcnt(0)
    v_cmp_ne_u32 vcc, 1, v60
    s_nop 0
    s_cbranch_vccz FDQF_2
    s_sleep 1
    s_sub_u32 s21, s21, 1
    s_cbranch_scc0 FWQF_1
FDQF_2:
    v_and_b32 v2, 15, v0
    v_lshlrev_b32 v6, 8, v2
    v_lshrrev_b32 v56, 4, v0
    v_lshl_add_u32 v6, v56, 4, v6
    ds_read_b32 v58, v4 offset:1024
    v_cmp_gt_u32 s[36:37], 4, v2
    s_lshl_b32 s14, s3, 11
    v_lshlrev_b32 v93, 9, v2
    v_lshl_add_u32 v93, v56, 4, v93
    v_add_u32 v93, s14, v93
    s_lshl_b32 s14, s3, 3
    v_lshlrev_b32 v94, 5, v2
    v_add_u32 v94, s14, v94
    s_mov_b64 exec, s[36:37]
    ds_read_b128 v[8:11], v6 offset:0
    ds_read_b128 v[12:15], v6 offset:64
    ds_read_b128 v[16:19], v6 offset:128
    ds_read_b128 v[20:23], v6 offset:192
    s_mov_b64 exec, -1
    s_lshl_b32 s16, s10, 2
    s_add_u32 s16, s16, s3
    s_lshl_b32 s32, s16, 6
    s_add_u32 s32, s32, s11
    s_lshl_b32 s32, s32, 7
    s_add_u32 s32, s32, 1048576
    s_lshl_b32 s16, s16, 4
    s_add_u32 s16, s16, s11
    s_lshl_b32 s33, s16, 7
    s_add_u32 s33, s33, 262144
    s_cmp_eq_u32 s91, 1
    s_cselect_b32 s18, 5, 8
    s_mov_b32 s84, 87380
    s_cselect_b32 s84, 1364, s84
    s_mov_b32 s85, -1
    v_add_u32 v92, s39, v5
    s_waitcnt lgkmcnt(0)
    v_readfirstlane_b32 s20, v58
    s_branch L_LOOP
L_PERMW:
    v_perm_b32 v76, v116, v112, s22
    v_perm_b32 v77, v124, v120, s22
    v_perm_b32 v78, v116, v112, s23
    v_perm_b32 v79, v124, v120, s23
    v_perm_b32 v80, v117, v113, s22
    v_perm_b32 v81, v125, v121, s22
    v_perm_b32 v82, v117, v113, s23
    v_perm_b32 v83, v125, v121, s23
    v_perm_b32 v84, v118, v114, s22
    v_perm_b32 v85, v126, v122, s22
    v_perm_b32 v86, v118, v114, s23
    v_perm_b32 v87, v126, v122, s23
    v_perm_b32 v88, v119, v115, s22
    v_perm_b32 v89, v127, v123, s22
    v_perm_b32 v90, v119, v115, s23
    v_perm_b32 v91, v127, v123, s23
    s_branch L_PV
L_BACK:
    s_add_u32 s85, s85, 1
    s_cmp_eq_u32 s85, 0
    s_cbranch_scc1 L_REGIT
    s_cmp_eq_u32 s85, 1
    s_cbranch_scc1 L_CP0
    s_cmp_eq_u32 s85, 2
    s_cbranch_scc1 L_CP1
    s_cmp_eq_u32 s85, 3
    s_cbranch_scc1 L_CP2
    ds_read_b128 v[96:99], v92 offset:0
    ds_read_b128 v[100:103], v92 offset:1024
    ds_read_b128 v[104:107], v92 offset:2048
    ds_read_b128 v[108:111], v92 offset:3072
    ds_read_b128 v[112:115], v92 offset:4096
    ds_read_b128 v[116:119], v92 offset:5120
    ds_read_b128 v[120:123], v92 offset:6144
    ds_read_b128 v[124:127], v92 offset:7168
    v_add_u32 v92, 0x2000, v92
    s_waitcnt lgkmcnt(0)
    s_branch L_REGIT
L_CP0:
    v_mov_b64 v[96:97], v[160:161]
    v_mov_b64 v[98:99], v[162:163]
    v_mov_b64 v[100:101], v[164:165]
    v_mov_b64 v[102:103], v[166:167]
    v_mov_b64 v[104:105], v[168:169]
    v_mov_b64 v[106:107], v[170:171]
    v_mov_b64 v[108:109], v[172:173]
    v_mov_b64 v[110:111], v[174:175]
    v_mov_b64 v[112:113], v[176:177]
    v_mov_b64 v[114:115], v[178:179]
    v_mov_b64 v[116:117], v[180:181]
    v_mov_b64 v[118:119], v[182:183]
    v_mov_b64 v[120:121], v[184:185]
    v_mov_b64 v[122:123], v[186:187]
    v_mov_b64 v[124:125], v[188:189]
    v_mov_b64 v[126:127], v[190:191]
    s_branch L_REGIT
L_CP1:
    v_mov_b64 v[96:97], v[192:193]
    v_mov_b64 v[98:99], v[194:195]
    v_mov_b64 v[100:101], v[196:197]
    v_mov_b64 v[102:103], v[198:199]
    v_mov_b64 v[104:105], v[200:201]
    v_mov_b64 v[106:107], v[202:203]
    v_mov_b64 v[108:109], v[204:205]
    v_mov_b64 v[110:111], v[206:207]
    v_mov_b64 v[112:113], v[208:209]
    v_mov_b64 v[114:115], v[210:211]
    v_mov_b64 v[116:117], v[212:213]
    v_mov_b64 v[118:119], v[214:215]
    v_mov_b64 v[120:121], v[216:217]
    v_mov_b64 v[122:123], v[218:219]
    v_mov_b64 v[124:125], v[220:221]
    v_mov_b64 v[126:127], v[222:223]
    s_branch L_REGIT
L_CP2:
    v_mov_b64 v[96:97], v[224:225]
    v_mov_b64 v[98:99], v[226:227]
    v_mov_b64 v[100:101], v[228:229]
    v_mov_b64 v[102:103], v[230:231]
    v_mov_b64 v[104:105], v[232:233]
    v_mov_b64 v[106:107], v[234:235]
    v_mov_b64 v[108:109], v[236:237]
    v_mov_b64 v[110:111], v[238:239]
    v_mov_b64 v[112:113], v[240:241]
    v_mov_b64 v[114:115], v[242:243]
    v_mov_b64 v[116:117], v[244:245]
    v_mov_b64 v[118:119], v[246:247]
    v_mov_b64 v[120:121], v[248:249]
    v_mov_b64 v[122:123], v[250:251]
    v_mov_b64 v[124:125], v[252:253]
    v_mov_b64 v[126:127], v[254:255]
L_REGIT:
    s_mov_b32 s38, 1
    v_mfma_f32_16x16x32_bf16 v[56:59], v[96:99], v[8:11], 0
    v_mfma_f32_16x16x32_bf16 v[56:59], v[100:103], v[12:15], v[56:59]
    v_mfma_f32_16x16x32_bf16 v[56:59], v[104:107], v[16:19], v[56:59]
    v_mfma_f32_16x16x32_bf16 v[56:59], v[108:111], v[20:23], v[56:59]
    s_nop 6
    s_branch L_SOFT
L_DYN:
    s_waitcnt lgkmcnt(0)
    s_cmp_eq_u32 s83, 1
    s_cbranch_scc1 L_SW2
    s_cmp_ge_u32 s90, 4
    s_cbranch_scc1 L_SWITCH
    s_mov_b32 s15, 31
    s_mov_b32 s14, 0
    s_cmp_ge_u32 s90, 1
    s_cselect_b32 s15, 30, s15
    s_cselect_b32 s14, 1, s14
    s_cmp_ge_u32 s90, 2
    s_cselect_b32 s15, 29, s15
    s_cselect_b32 s14, 2, s14
    s_cmp_ge_u32 s90, 3
    s_cselect_b32 s15, 28, s15
    s_cselect_b32 s14, 3, s14
    s_add_u32 s15, s15, s90
    s_mov_b32 s16, s86
    s_and_b32 s15, s15, 31
    s_lshl_b32 s15, s15, 6
    s_add_u32 s15, s15, s16
    s_lshr_b32 s16, s16, 1
    s_and_b32 s16, s16, 6
    s_sub_u32 s16, s10, s16
    s_bfe_u32 s16, s16, 0x10003
    s_xor_b32 s16, s16, s14
    s_lshl_b32 s16, s16, 4
    s_add_u32 s15, s15, s16
    s_lshl_b32 s15, s15, 12
    s_lshr_b32 s14, s15, 6
    s_and_b32 s14, s14, 0x200
    s_and_b32 s15, s15, 0xffff7fff
    s_or_b32 s15, s15, s14
    s_branch L_HAVE
L_SWITCH:
    s_mov_b32 s83, 1
    s_mov_b64 s[28:29], s[30:31]
L_SW2:
    s_mov_b32 s90, 1
    s_atomic_add s90, s[28:29], 0 glc
    s_mov_b32 s38, 4
    s_branch L_SOFT
L_DEFER:
    v_mfma_f32_16x16x16_bf16 v[24:27], v[76:77], v[70:71], v[24:27]
    v_mfma_f32_16x16x16_bf16 v[28:31], v[78:79], v[70:71], v[28:31]
    v_mfma_f32_16x16x16_bf16 v[32:35], v[80:81], v[70:71], v[32:35]
    v_mfma_f32_16x16x16_bf16 v[36:39], v[82:83], v[70:71], v[36:39]
    v_mfma_f32_16x16x16_bf16 v[40:43], v[84:85], v[70:71], v[40:43]
    v_mfma_f32_16x16x16_bf16 v[44:47], v[86:87], v[70:71], v[44:47]
    v_mfma_f32_16x16x16_bf16 v[48:51], v[88:89], v[70:71], v[48:51]
    v_mfma_f32_16x16x16_bf16 v[52:55], v[90:91], v[70:71], v[52:55]
    s_waitcnt lgkmcnt(0)
    s_mov_b32 s38, 2
    s_cmp_ge_u32 s90, 28
    s_cbranch_scc1 L_PVX
    s_mov_b32 s15, 128
    s_mov_b32 s14, 0
    s_cmp_ge_u32 s90, 8
    s_cselect_b32 s15, 120, s15
    s_cselect_b32 s14, 1, s14
    s_cmp_ge_u32 s90, 16
    s_cselect_b32 s15, 112, s15
    s_cselect_b32 s14, 2, s14
    s_add_u32 s15, s15, s90
    s_and_b32 s16, s15, 3
    s_lshl_b32 s16, s16, 2
    s_add_u32 s16, s16, s3
    s_lshr_b32 s15, s15, 2
    s_and_b32 s15, s15, 31
    s_lshl_b32 s15, s15, 6
    s_add_u32 s15, s15, s16
    s_lshr_b32 s16, s16, 1
    s_and_b32 s16, s16, 6
    s_sub_u32 s16, s10, s16
    s_bfe_u32 s16, s16, 0x10003
    s_xor_b32 s16, s16, s14
    s_lshl_b32 s16, s16, 4
    s_add_u32 s15, s15, s16
    s_lshl_b32 s15, s15, 12
    s_lshr_b32 s14, s15, 6
    s_and_b32 s14, s14, 0x200
    s_and_b32 s15, s15, 0xffff7fff
    s_or_b32 s15, s15, s14
L_DEFH:
    s_mov_b32 s38, 0
    s_lshr_b32 s19, s15, 8
    s_and_b32 s19, s19, 0x3000
    s_xor_b32 s19, s19, s15
    s_lshr_b32 s81, s15, 5
    s_and_b32 s81, s81, 0x4000
    s_xor_b32 s19, s19, s81
    s_lshr_b32 s81, s15, 12
    s_and_b32 s81, s81, 0x200
    s_xor_b32 s19, s19, s81
    s_add_u32 s24, s4, s19
    s_addc_u32 s25, s5, 0
    global_load_dwordx4 v[128:131], v1, s[24:25] offset:0 nt
    global_load_dwordx4 v[132:135], v1, s[24:25] offset:64 nt
    global_load_dwordx4 v[136:139], v1, s[24:25] offset:128 nt
    global_load_dwordx4 v[140:143], v1, s[24:25] offset:192 nt
    s_add_u32 s26, s6, s19
    s_addc_u32 s27, s7, 0
    global_load_dwordx4 v[144:147], v69, s[26:27] offset:0 nt
    global_load_dwordx4 v[148:151], v69, s[26:27] offset:1024 nt
    global_load_dwordx4 v[152:155], v69, s[26:27] offset:2048 nt
    global_load_dwordx4 v[156:159], v69, s[26:27] offset:3072 nt
    s_branch L_PVX
L_DYNG:
    s_mov_b32 s38, 2
    s_cmp_ge_u32 s90, 28
    s_cbranch_scc1 L_TRIG
    s_mov_b32 s15, 128
    s_mov_b32 s14, 0
    s_cmp_ge_u32 s90, 8
    s_cselect_b32 s15, 120, s15
    s_cselect_b32 s14, 1, s14
    s_cmp_ge_u32 s90, 16
    s_cselect_b32 s15, 112, s15
    s_cselect_b32 s14, 2, s14
    s_add_u32 s15, s15, s90
    s_and_b32 s16, s15, 3
    s_lshl_b32 s16, s16, 2
    s_add_u32 s16, s16, s3
    s_lshr_b32 s15, s15, 2
    s_and_b32 s15, s15, 31
    s_lshl_b32 s15, s15, 6
    s_add_u32 s15, s15, s16
    s_lshr_b32 s16, s16, 1
    s_and_b32 s16, s16, 6
    s_sub_u32 s16, s10, s16
    s_bfe_u32 s16, s16, 0x10003
    s_xor_b32 s16, s16, s14
    s_lshl_b32 s16, s16, 4
    s_add_u32 s15, s15, s16
    s_lshl_b32 s15, s15, 12
    s_lshr_b32 s14, s15, 6
    s_and_b32 s14, s14, 0x200
    s_and_b32 s15, s15, 0xffff7fff
    s_or_b32 s15, s15, s14
    s_mov_b32 s38, 0
    s_branch L_HAVE
L_TRIG:
    s_branch L_SOFT
L_LOOP:
    s_lshr_b32 s84, s84, 1
    s_bitcmp1_b32 s84, 0
    s_cbranch_scc1 L_BACK
    s_waitcnt vmcnt(4)
    v_mfma_f32_16x16x32_bf16 v[56:59], v[128:131], v[8:11], 0
    v_mfma_f32_16x16x32_bf16 v[56:59], v[132:135], v[12:15], v[56:59]
    v_mfma_f32_16x16x32_bf16 v[56:59], v[136:139], v[16:19], v[56:59]
    v_mfma_f32_16x16x32_bf16 v[56:59], v[140:143], v[20:23], v[56:59]
    s_mov_b32 s38, 0
    s_add_u32 s15, s15, 262144
    s_cmp_ge_u32 s18, s87
    s_cbranch_scc1 L_DYN
L_HAVE:
    s_lshr_b32 s19, s15, 8
    s_and_b32 s19, s19, 0x3000
    s_xor_b32 s19, s19, s15
    s_lshr_b32 s81, s15, 5
    s_and_b32 s81, s81, 0x4000
    s_xor_b32 s19, s19, s81
    s_lshr_b32 s81, s15, 12
    s_and_b32 s81, s81, 0x200
    s_xor_b32 s19, s19, s81
    s_add_u32 s24, s4, s19
    s_addc_u32 s25, s5, 0
    global_load_dwordx4 v[128:131], v1, s[24:25] offset:0 nt
    global_load_dwordx4 v[132:135], v1, s[24:25] offset:64 nt
    global_load_dwordx4 v[136:139], v1, s[24:25] offset:128 nt
    global_load_dwordx4 v[140:143], v1, s[24:25] offset:192 nt
    s_add_u32 s18, s18, 1
L_SOFT:
    v_cvt_pk_bf16_f32 v64, v56, v57
    v_lshlrev_b32 v60, 16, v64
    v_and_b32 v61, 0xffff0000, v64
    v_cvt_pk_bf16_f32 v65, v58, v59
    v_lshlrev_b32 v62, 16, v65
    v_and_b32 v63, 0xffff0000, v65
    v_mul_f32 v60, s34, v60
    v_mul_f32 v61, s34, v61
    v_mul_f32 v62, s34, v62
    v_mul_f32 v63, s34, v63
    v_cvt_pk_bf16_f32 v64, v60, v61
    v_lshlrev_b32 v60, 16, v64
    v_and_b32 v61, 0xffff0000, v64
    v_cvt_pk_bf16_f32 v65, v62, v63
    v_lshlrev_b32 v62, 16, v65
    v_and_b32 v63, 0xffff0000, v65
    v_max3_f32 v64, v60, v61, v62
    v_max3_f32 v64, v64, v63, v72
    v_mov_b32 v65, v64
    s_nop 1
    v_permlane32_swap_b32 v64, v65
    v_max_f32 v64, v64, v65
    v_mov_b32 v65, v64
    s_nop 1
    v_permlane16_swap_b32 v64, v65
    v_max_f32 v72, v64, v65
    v_mul_f32 v64, s35, v72
    v_sub_f32 v75, v73, v64
    v_mov_b32 v73, v64
    v_exp_f32 v75, v75
    v_fma_f32 v60, v60, s35, -v73
    v_fma_f32 v61, v61, s35, -v73
    v_fma_f32 v62, v62, s35, -v73
    v_fma_f32 v63, v63, s35, -v73
    v_exp_f32 v60, v60
    v_exp_f32 v61, v61
    v_exp_f32 v62, v62
    v_exp_f32 v63, v63
    v_pk_mul_f32 v[24:25], v[24:25], v[74:75] op_sel:[0,1] op_sel_hi:[1,1]
    v_pk_mul_f32 v[26:27], v[26:27], v[74:75] op_sel:[0,1] op_sel_hi:[1,1]
    v_pk_mul_f32 v[28:29], v[28:29], v[74:75] op_sel:[0,1] op_sel_hi:[1,1]
    v_pk_mul_f32 v[30:31], v[30:31], v[74:75] op_sel:[0,1] op_sel_hi:[1,1]
    v_pk_mul_f32 v[32:33], v[32:33], v[74:75] op_sel:[0,1] op_sel_hi:[1,1]
    v_pk_mul_f32 v[34:35], v[34:35], v[74:75] op_sel:[0,1] op_sel_hi:[1,1]
    v_pk_mul_f32 v[36:37], v[36:37], v[74:75] op_sel:[0,1] op_sel_hi:[1,1]
    v_pk_mul_f32 v[38:39], v[38:39], v[74:75] op_sel:[0,1] op_sel_hi:[1,1]
    v_pk_mul_f32 v[40:41], v[40:41], v[74:75] op_sel:[0,1] op_sel_hi:[1,1]
    v_pk_mul_f32 v[42:43], v[42:43], v[74:75] op_sel:[0,1] op_sel_hi:[1,1]
    v_pk_mul_f32 v[44:45], v[44:45], v[74:75] op_sel:[0,1] op_sel_hi:[1,1]
    v_pk_mul_f32 v[46:47], v[46:47], v[74:75] op_sel:[0,1] op_sel_hi:[1,1]
    v_pk_mul_f32 v[48:49], v[48:49], v[74:75] op_sel:[0,1] op_sel_hi:[1,1]
    v_pk_mul_f32 v[50:51], v[50:51], v[74:75] op_sel:[0,1] op_sel_hi:[1,1]
    v_pk_mul_f32 v[52:53], v[52:53], v[74:75] op_sel:[0,1] op_sel_hi:[1,1]
    v_pk_mul_f32 v[54:55], v[54:55], v[74:75] op_sel:[0,1] op_sel_hi:[1,1]
    v_mul_f32 v74, v74, v75
    v_add_f32 v64, v60, v61
    v_add_f32 v65, v62, v63
    v_cvt_pk_bf16_f32 v70, v60, v61
    v_cvt_pk_bf16_f32 v71, v62, v63
    v_add_f32 v64, v64, v65
    v_add_f32 v74, v74, v64
    s_cmp_eq_u32 s38, 1
    s_cbranch_scc1 L_PERMW
    s_cmp_eq_u32 s38, 0
    s_cbranch_scc1 L_W4
    s_waitcnt vmcnt(0)
L_W4:
    s_waitcnt vmcnt(4)
    v_perm_b32 v76, v148, v144, s22
    v_perm_b32 v77, v156, v152, s22
    v_perm_b32 v78, v148, v144, s23
    v_perm_b32 v79, v156, v152, s23
    v_perm_b32 v80, v149, v145, s22
    v_perm_b32 v81, v157, v153, s22
    v_perm_b32 v82, v149, v145, s23
    v_perm_b32 v83, v157, v153, s23
    v_perm_b32 v84, v150, v146, s22
    v_perm_b32 v85, v158, v154, s22
    v_perm_b32 v86, v150, v146, s23
    v_perm_b32 v87, v158, v154, s23
    v_perm_b32 v88, v151, v147, s22
    v_perm_b32 v89, v159, v155, s22
    v_perm_b32 v90, v151, v147, s23
    v_perm_b32 v91, v159, v155, s23
    s_cmp_eq_u32 s38, 0
    s_cbranch_scc1 L_LDV
    s_cmp_eq_u32 s38, 4
    s_cbranch_scc1 L_DEFER
    s_branch L_PV
L_LDV:
    s_add_u32 s26, s6, s19
    s_addc_u32 s27, s7, 0
    global_load_dwordx4 v[144:147], v69, s[26:27] offset:0 nt
    global_load_dwordx4 v[148:151], v69, s[26:27] offset:1024 nt
    global_load_dwordx4 v[152:155], v69, s[26:27] offset:2048 nt
    global_load_dwordx4 v[156:159], v69, s[26:27] offset:3072 nt
    s_cmp_le_u32 s18, s88
    s_cbranch_scc1 L_PV
    s_cmp_eq_u32 s83, 1
    s_cbranch_scc1 L_PV
    s_mov_b32 s90, 1
    s_atomic_add s90, s[28:29], 0 glc
L_PV:
    v_mfma_f32_16x16x16_bf16 v[24:27], v[76:77], v[70:71], v[24:27]
    v_mfma_f32_16x16x16_bf16 v[28:31], v[78:79], v[70:71], v[28:31]
    v_mfma_f32_16x16x16_bf16 v[32:35], v[80:81], v[70:71], v[32:35]
    v_mfma_f32_16x16x16_bf16 v[36:39], v[82:83], v[70:71], v[36:39]
    v_mfma_f32_16x16x16_bf16 v[40:43], v[84:85], v[70:71], v[40:43]
    v_mfma_f32_16x16x16_bf16 v[44:47], v[86:87], v[70:71], v[44:47]
    v_mfma_f32_16x16x16_bf16 v[48:51], v[88:89], v[70:71], v[48:51]
    v_mfma_f32_16x16x16_bf16 v[52:55], v[90:91], v[70:71], v[52:55]
L_PVX:
    s_cmp_lg_u32 s38, 2
    s_cbranch_scc1 L_LOOP
    s_setprio 3
    s_mov_b64 exec, s[36:37]
    ds_write_b128 v93, v[24:27] offset:3584
    ds_write_b128 v93, v[28:31] offset:3648
    ds_write_b128 v93, v[32:35] offset:3712
    ds_write_b128 v93, v[36:39] offset:3776
    ds_write_b128 v93, v[40:43] offset:3840
    ds_write_b128 v93, v[44:47] offset:3904
    ds_write_b128 v93, v[48:51] offset:3968
    ds_write_b128 v93, v[52:55] offset:4032
    s_mov_b64 exec, -1
    v_mov_b32 v3, 1
    s_mov_b64 exec, 1
    ds_add_u32 v4, v3 offset:1096
    s_mov_b64 exec, -1
    v_mov_b32 v60, v74
    s_nop 1
    v_permlane32_swap_b32 v74, v60
    v_add_f32 v74, v74, v60
    v_mov_b32 v60, v74
    s_nop 1
    v_permlane16_swap_b32 v74, v60
    v_add_f32 v73, v74, v60
    s_mov_b64 exec, s[36:37]
    ds_write_b64 v94, v[72:73] offset:3360
    s_mov_b64 exec, -1
    v_and_b32 v1, 15, v0
    v_lshrrev_b32 v6, 4, v0
    s_lshl_b32 s16, s3, 9
    v_and_b32 v8, 0x1f0, v5
    v_add_u32 v8, s16, v8
    v_bfe_u32 v10, v0, 3, 2
    v_lshlrev_b32 v10, 11, v10
    v_and_b32 v12, 0x70, v5
    v_add3_u32 v10, v10, v12, s32
    s_lshl_b32 s16, s3, 5
    v_mov_b32 v9, s16
    s_mov_b32 s24, 0x07060501
    s_mov_b32 s25, 0x07060502
    s_mov_b32 s26, 0x07060503
    s_mov_b32 s28, 0xaaaaaaaa
    s_mov_b32 s29, 0xaaaaaaaa
    s_waitcnt lgkmcnt(0)
    s_barrier
L_DS2:
    ds_read_b32 v70, v4 offset:1152
    ds_read_b128 v[60:63], v9 offset:3360
    ds_read_b128 v[64:67], v9 offset:3376
    ds_read_b128 v[24:27], v8 offset:3584
    ds_read_b128 v[28:31], v8 offset:5632
    ds_read_b128 v[32:35], v8 offset:7680
    ds_read_b128 v[36:39], v8 offset:9728
    s_waitcnt lgkmcnt(4)
    v_max3_f32 v84, v60, v62, v64
    v_max_f32 v84, v84, v66
    v_xor_b32 v10, v10, v70
    v_mul_f32 v12, s35, v84
    v_mul_f32 v60, s35, v60
    v_mul_f32 v62, s35, v62
    v_mul_f32 v64, s35, v64
    v_mul_f32 v66, s35, v66
    v_sub_f32 v60, v60, v12
    v_sub_f32 v62, v62, v12
    v_sub_f32 v64, v64, v12
    v_sub_f32 v66, v66, v12
    v_exp_f32 v60, v60
    v_exp_f32 v62, v62
    v_exp_f32 v64, v64
    v_exp_f32 v66, v66
    s_waitcnt lgkmcnt(0)
    v_pk_mul_f32 v[82:83], v[26:27], v[60:61] op_sel_hi:[1,0]
    v_pk_mul_f32 v[80:81], v[24:25], v[60:61] op_sel_hi:[1,0]
    v_mul_f32 v86, v60, v61
    v_pk_fma_f32 v[82:83], v[30:31], v[62:63], v[82:83] op_sel_hi:[1,0,1]
    v_pk_fma_f32 v[80:81], v[28:29], v[62:63], v[80:81] op_sel_hi:[1,0,1]
    v_fmac_f32 v86, v62, v63
    v_pk_fma_f32 v[82:83], v[34:35], v[64:65], v[82:83] op_sel_hi:[1,0,1]
    v_pk_fma_f32 v[80:81], v[32:33], v[64:65], v[80:81] op_sel_hi:[1,0,1]
    v_fmac_f32 v86, v64, v65
    v_pk_fma_f32 v[82:83], v[38:39], v[66:67], v[82:83] op_sel_hi:[1,0,1]
    v_pk_fma_f32 v[80:81], v[36:37], v[66:67], v[80:81] op_sel_hi:[1,0,1]
    v_fmac_f32 v86, v66, v67
    s_mov_b32 exec_hi, 0
    v_perm_b32 v90, v82, v83, s26
    v_perm_b32 v88, v80, v83, s24
    v_perm_b32 v89, v81, v83, s25
    v_cndmask_b32 v91, v84, v86, s[28:29]
    s_cbranch_execz L_DC1
    global_store_dwordx4 v10, v[88:91], s[8:9] sc1
    s_mov_b64 exec, -1
    s_lshl_b32 s14, s3, 2
    v_mov_b32 v2, s14
    v_mov_b32 v3, 1
    ds_write_b32 v2, v3 offset:1136
    s_bfe_u32 s14, s76, 0x20004
    s_lshl_b32 s13, s14, 4
    s_and_b32 s14, s76, 7
    s_lshl_b32 s14, s14, 1
    s_add_u32 s13, s13, s14
    s_bfe_u32 s14, s76, 0x10003
    s_add_u32 s13, s13, s14
    s_lshr_b32 s14, s76, 6
    s_cmp_eq_u32 s14, 2
    s_cselect_b32 s13, s13, 99
    s_cmp_ge_u32 s13, 56
    s_cbranch_scc1 L_FIN
    v_and_b32 v1, 15, v0
    v_lshrrev_b32 v2, 4, v0
    v_mul_u32_u24 v10, 1040, v1
    v_lshl_add_u32 v10, v2, 4, v10
    s_mul_i32 s16, s3, 16640
    s_add_u32 s16, s16, 13824
    v_add_u32 v10, s16, v10
    v_mul_u32_u24 v11, 160, v1
    v_lshl_add_u32 v11, v2, 4, v11
    s_mul_i32 s16, s3, 10240
    s_add_u32 s16, s16, 80384
    v_add_u32 v11, s16, v11
    v_and_b32 v3, 1, v0
    v_lshlrev_b32 v12, 10, v3
    v_lshl_add_u32 v12, v2, 4, v12
    v_lshlrev_b32 v13, 6, v3
    v_lshl_add_u32 v14, v2, 4, v13
    v_add_u32 v14, 1184, v14
    v_lshl_add_u32 v13, v2, 2, v13
    s_lshl_b32 s16, s3, 4
    v_add_u32 v13, s16, v13
    v_mov_b32 v15, 1168
    v_bfe_u32 v3, v0, 1, 3
    v_cmp_eq_u32 vcc, 0, v3
    s_nop 1
    v_cndmask_b32 v28, v15, v14, vcc
    v_cmp_eq_u32 vcc, 1, v3
    s_nop 1
    v_cndmask_b32 v29, v15, v14, vcc
    v_cmp_eq_u32 vcc, 2, v3
    s_nop 1
    v_cndmask_b32 v30, v15, v14, vcc
    v_cmp_eq_u32 vcc, 3, v3
    s_nop 1
    v_cndmask_b32 v31, v15, v14, vcc
    v_cmp_eq_u32 vcc, 4, v3
    s_nop 1
    v_cndmask_b32 v32, v15, v14, vcc
    v_cmp_eq_u32 vcc, 5, v3
    s_nop 1
    v_cndmask_b32 v33, v15, v14, vcc
    v_cmp_eq_u32 vcc, 6, v3
    s_nop 1
    v_cndmask_b32 v34, v15, v14, vcc
    v_cmp_eq_u32 vcc, 7, v3
    s_nop 1
    v_cndmask_b32 v35, v15, v14, vcc
    v_cmp_gt_u32 s[42:43], 2, v1
    s_mul_i32 s14, s3, 65536
    s_lshl_b32 s15, s13, 7
    s_add_u32 s14, s14, s15
    s_add_u32 s14, s14, 1835008
    v_mul_u32_u24 v24, 8192, v3
    v_and_b32 v25, 1, v0
    v_lshlrev_b32 v25, 6, v25
    v_lshl_add_u32 v25, v2, 4, v25
    v_add3_u32 v24, v24, v25, s14
    v_xor_b32 v24, v24, v70
    s_mov_b32 s26, 0x3d372713
    s_mov_b32 s27, 0xc0135761
    ds_read_b128 v[96:99], v10 offset:0
    ds_read_b128 v[100:103], v10 offset:64
    ds_read_b128 v[104:107], v10 offset:128
    ds_read_b128 v[108:111], v10 offset:192
    ds_read_b128 v[112:115], v10 offset:256
    ds_read_b128 v[116:119], v10 offset:320
    ds_read_b128 v[120:123], v10 offset:384
    ds_read_b128 v[124:127], v10 offset:448
    ds_read_b128 v[128:131], v10 offset:512
    ds_read_b128 v[132:135], v10 offset:576
    ds_read_b128 v[136:139], v10 offset:640
    ds_read_b128 v[140:143], v10 offset:704
    ds_read_b128 v[144:147], v10 offset:768
    ds_read_b128 v[148:151], v10 offset:832
    ds_read_b128 v[152:155], v10 offset:896
    ds_read_b128 v[156:159], v10 offset:960
    s_lshl_b32 s14, s13, 15
    s_lshl_b32 s16, s3, 8
    s_add_u32 s14, s14, s16
    s_add_u32 s24, s52, s14
    s_addc_u32 s25, s53, 0
    s_add_u32 s28, s24, 4096
    s_addc_u32 s29, s25, 0
    v_lshlrev_b32 v20, 13, v2
    v_lshl_add_u32 v20, v1, 4, v20
    s_mul_i32 s39, s3, 8448
    s_add_u32 s39, s39, 80384
    v_bfe_u32 v21, v0, 2, 2
    v_mul_u32_u24 v21, 1056, v21
    v_lshl_add_u32 v21, v2, 8, v21
    v_and_b32 v22, 3, v0
    v_lshl_add_u32 v21, v22, 3, v21
    v_add_u32 v21, s39, v21
    s_waitcnt lgkmcnt(0)
    s_barrier
    s_sleep 5
    s_add_u32 m0, s39, 0
    s_nop 0
    global_load_lds_dwordx4 v20, s[24:25] offset:0 nt
    s_add_u32 m0, s39, 32
    s_nop 0
    global_load_lds_dwordx4 v20, s[24:25] offset:1024 nt
    s_add_u32 m0, s39, 64
    s_nop 0
    global_load_lds_dwordx4 v20, s[24:25] offset:2048 nt
    s_add_u32 m0, s39, 96
    s_nop 0
    global_load_lds_dwordx4 v20, s[24:25] offset:3072 nt
    s_add_u32 m0, s39, 4224
    s_nop 0
    global_load_lds_dwordx4 v20, s[28:29] offset:0 nt
    s_add_u32 m0, s39, 4256
    s_nop 0
    global_load_lds_dwordx4 v20, s[28:29] offset:1024 nt
    s_add_u32 m0, s39, 4288
    s_nop 0
    global_load_lds_dwordx4 v20, s[28:29] offset:2048 nt
    s_add_u32 m0, s39, 4320
    s_nop 0
    global_load_lds_dwordx4 v20, s[28:29] offset:3072 nt
    s_barrier
L_DC1:
    ds_read_b128 v[192:195], v12 offset:1312
    ds_read_b128 v[196:199], v12 offset:1376
    ds_read_b128 v[200:203], v12 offset:1440
    ds_read_b128 v[204:207], v12 offset:1504
    ds_read_b128 v[208:211], v12 offset:1568
    ds_read_b128 v[212:215], v12 offset:1632
    ds_read_b128 v[216:219], v12 offset:1696
    ds_read_b128 v[220:223], v12 offset:1760
    ds_read_b128 v[224:227], v12 offset:1824
    ds_read_b128 v[228:231], v12 offset:1888
    ds_read_b128 v[232:235], v12 offset:1952
    ds_read_b128 v[236:239], v12 offset:2016
    ds_read_b128 v[240:243], v12 offset:2080
    ds_read_b128 v[244:247], v12 offset:2144
    ds_read_b128 v[248:251], v12 offset:2208
    ds_read_b128 v[252:255], v12 offset:2272
    s_waitcnt lgkmcnt(15)
    v_mfma_f32_16x16x32_bf16 v[40:43], v[96:99], v[192:195], 0
    s_waitcnt lgkmcnt(14)
    v_mfma_f32_16x16x32_bf16 v[40:43], v[100:103], v[196:199], v[40:43]
    s_waitcnt lgkmcnt(13)
    v_mfma_f32_16x16x32_bf16 v[40:43], v[104:107], v[200:203], v[40:43]
    s_waitcnt lgkmcnt(12)
    v_mfma_f32_16x16x32_bf16 v[40:43], v[108:111], v[204:207], v[40:43]
    s_waitcnt lgkmcnt(11)
    v_mfma_f32_16x16x32_bf16 v[40:43], v[112:115], v[208:211], v[40:43]
    s_waitcnt lgkmcnt(10)
    v_mfma_f32_16x16x32_bf16 v[40:43], v[116:119], v[212:215], v[40:43]
    s_waitcnt lgkmcnt(9)
    v_mfma_f32_16x16x32_bf16 v[40:43], v[120:123], v[216:219], v[40:43]
    s_waitcnt lgkmcnt(8)
    v_mfma_f32_16x16x32_bf16 v[40:43], v[124:127], v[220:223], v[40:43]
    s_waitcnt lgkmcnt(7)
    v_mfma_f32_16x16x32_bf16 v[40:43], v[128:131], v[224:227], v[40:43]
    s_waitcnt lgkmcnt(6)
    v_mfma_f32_16x16x32_bf16 v[40:43], v[132:135], v[228:231], v[40:43]
    s_waitcnt lgkmcnt(5)
    v_mfma_f32_16x16x32_bf16 v[40:43], v[136:139], v[232:235], v[40:43]
    s_waitcnt lgkmcnt(4)
    v_mfma_f32_16x16x32_bf16 v[40:43], v[140:143], v[236:239], v[40:43]
    s_waitcnt lgkmcnt(3)
    v_mfma_f32_16x16x32_bf16 v[40:43], v[144:147], v[240:243], v[40:43]
    s_waitcnt lgkmcnt(2)
    v_mfma_f32_16x16x32_bf16 v[40:43], v[148:151], v[244:247], v[40:43]
    s_waitcnt lgkmcnt(1)
    v_mfma_f32_16x16x32_bf16 v[40:43], v[152:155], v[248:251], v[40:43]
    s_waitcnt lgkmcnt(0)
    v_mfma_f32_16x16x32_bf16 v[40:43], v[156:159], v[252:255], v[40:43]
    s_waitcnt vmcnt(0)
    ds_read_b64_tr_b16 v[160:161], v21 offset:0
    ds_read_b64_tr_b16 v[162:163], v21 offset:4224
    ds_read_b64_tr_b16 v[164:165], v21 offset:32
    ds_read_b64_tr_b16 v[166:167], v21 offset:4256
    ds_read_b64_tr_b16 v[168:169], v21 offset:64
    ds_read_b64_tr_b16 v[170:171], v21 offset:4288
    ds_read_b64_tr_b16 v[172:173], v21 offset:96
    ds_read_b64_tr_b16 v[174:175], v21 offset:4320
    ds_read_b64_tr_b16 v[176:177], v21 offset:128
    ds_read_b64_tr_b16 v[178:179], v21 offset:4352
    ds_read_b64_tr_b16 v[180:181], v21 offset:160
    ds_read_b64_tr_b16 v[182:183], v21 offset:4384
    ds_read_b64_tr_b16 v[184:185], v21 offset:192
    ds_read_b64_tr_b16 v[186:187], v21 offset:4416
    ds_read_b64_tr_b16 v[188:189], v21 offset:224
    ds_read_b64_tr_b16 v[190:191], v21 offset:4448
    v_cvt_pk_bf16_f32 v44, v40, v41
    v_lshlrev_b32 v40, 16, v44
    v_and_b32 v41, 0xffff0000, v44
    v_cvt_pk_bf16_f32 v45, v42, v43
    v_lshlrev_b32 v42, 16, v45
    v_and_b32 v43, 0xffff0000, v45
    v_mul_f32 v44, v40, v40
    v_mul_f32 v45, v42, v42
    v_fma_f32 v44, v44, s26, 1.0
    v_fma_f32 v45, v45, s26, 1.0
    v_mul_f32 v44, v44, v40
    v_mul_f32 v45, v45, v42
    v_mul_f32 v44, s27, v44
    v_mul_f32 v45, s27, v45
    v_exp_f32 v44, v44
    v_exp_f32 v45, v45
    v_add_f32 v44, 1.0, v44
    v_add_f32 v45, 1.0, v45
    v_rcp_f32 v44, v44
    v_rcp_f32 v45, v45
    v_mul_f32 v44, v44, v40
    v_mul_f32 v45, v45, v42
    v_cvt_pk_bf16_f32 v46, v44, v45
    v_lshlrev_b32 v44, 16, v46
    v_and_b32 v45, 0xffff0000, v46
    v_mul_f32 v44, v44, v41
    v_mul_f32 v45, v45, v43
    v_cvt_pk_bf16_f32 v44, v44, v45
    s_cbranch_execz L_DC2
    s_mov_b64 exec, s[42:43]
    ds_write_b32 v13, v44 offset:1184
    s_mov_b64 exec, -1
    s_waitcnt lgkmcnt(0)
    s_barrier
L_DC2:
    ds_read_b128 v[192:195], v28
    ds_read_b128 v[196:199], v29
    ds_read_b128 v[200:203], v30
    ds_read_b128 v[204:207], v31
    ds_read_b128 v[208:211], v32
    ds_read_b128 v[212:215], v33
    ds_read_b128 v[216:219], v34
    ds_read_b128 v[220:223], v35
    s_waitcnt lgkmcnt(7)
    v_mfma_f32_16x16x32_bf16 v[64:67], v[160:163], v[192:195], 0
    s_waitcnt lgkmcnt(6)
    v_mfma_f32_16x16x32_bf16 v[64:67], v[164:167], v[196:199], v[64:67]
    s_waitcnt lgkmcnt(5)
    v_mfma_f32_16x16x32_bf16 v[64:67], v[168:171], v[200:203], v[64:67]
    s_waitcnt lgkmcnt(4)
    v_mfma_f32_16x16x32_bf16 v[64:67], v[172:175], v[204:207], v[64:67]
    s_waitcnt lgkmcnt(3)
    v_mfma_f32_16x16x32_bf16 v[64:67], v[176:179], v[208:211], v[64:67]
    s_waitcnt lgkmcnt(2)
    v_mfma_f32_16x16x32_bf16 v[64:67], v[180:183], v[212:215], v[64:67]
    s_waitcnt lgkmcnt(1)
    v_mfma_f32_16x16x32_bf16 v[64:67], v[184:187], v[216:219], v[64:67]
    s_waitcnt lgkmcnt(0)
    v_mfma_f32_16x16x32_bf16 v[64:67], v[188:191], v[220:223], v[64:67]
    s_cbranch_execz L_DDONE
    s_nop 6
    global_store_dwordx4 v24, v[64:67], s[8:9] sc1
L_FIN:
L_END:
    s_endpgm
L_HOLD:
    s_barrier
    s_mov_b32 s82, s13
    s_bfe_u32 s14, s76, 0x20004
    s_lshl_b32 s13, s14, 4
    s_and_b32 s14, s76, 7
    s_lshl_b32 s14, s14, 1
    s_add_u32 s13, s13, s14
    s_bfe_u32 s14, s76, 0x10003
    s_add_u32 s13, s13, s14
    s_lshr_b32 s14, s76, 6
    s_cmp_eq_u32 s14, 2
    s_cselect_b32 s13, s13, 99
    s_cmp_ge_u32 s13, 56
    s_cbranch_scc1 L_HOLDB
    s_lshl_b32 s14, s3, 4
    v_lshrrev_b32 v8, 2, v0
    v_add_u32 v8, s14, v8
    v_and_b32 v9, 3, v0
    s_mov_b32 s16, 28672
    v_mul_lo_u32 v6, v8, s16
    v_lshl_add_u32 v6, v9, 4, v6
    s_lshl_b32 s14, s13, 6
    s_add_u32 s24, s48, s14
    s_addc_u32 s25, s49, 0
    global_load_dwordx4 v[96:99], v6, s[24:25] nt
    s_add_u32 s24, s24, 3584
    s_addc_u32 s25, s25, 0
    global_load_dwordx4 v[100:103], v6, s[24:25] nt
    s_add_u32 s24, s24, 3584
    s_addc_u32 s25, s25, 0
    global_load_dwordx4 v[104:107], v6, s[24:25] nt
    s_add_u32 s24, s24, 3584
    s_addc_u32 s25, s25, 0
    global_load_dwordx4 v[108:111], v6, s[24:25] nt
    s_add_u32 s24, s24, 3584
    s_addc_u32 s25, s25, 0
    global_load_dwordx4 v[112:115], v6, s[24:25] nt
    s_add_u32 s24, s24, 3584
    s_addc_u32 s25, s25, 0
    global_load_dwordx4 v[116:119], v6, s[24:25] nt
    s_add_u32 s24, s24, 3584
    s_addc_u32 s25, s25, 0
    global_load_dwordx4 v[120:123], v6, s[24:25] nt
    s_add_u32 s24, s24, 3584
    s_addc_u32 s25, s25, 0
    global_load_dwordx4 v[124:127], v6, s[24:25] nt
    s_lshl_b32 s14, s13, 6
    s_add_u32 s24, s50, s14
    s_addc_u32 s25, s51, 0
    global_load_dwordx4 v[128:131], v6, s[24:25] nt
    s_add_u32 s24, s24, 3584
    s_addc_u32 s25, s25, 0
    global_load_dwordx4 v[132:135], v6, s[24:25] nt
    s_add_u32 s24, s24, 3584
    s_addc_u32 s25, s25, 0
    global_load_dwordx4 v[136:139], v6, s[24:25] nt
    s_add_u32 s24, s24, 3584
    s_addc_u32 s25, s25, 0
    global_load_dwordx4 v[140:143], v6, s[24:25] nt
    s_add_u32 s24, s24, 3584
    s_addc_u32 s25, s25, 0
    global_load_dwordx4 v[144:147], v6, s[24:25] nt
    s_add_u32 s24, s24, 3584
    s_addc_u32 s25, s25, 0
    global_load_dwordx4 v[148:151], v6, s[24:25] nt
    s_add_u32 s24, s24, 3584
    s_addc_u32 s25, s25, 0
    global_load_dwordx4 v[152:155], v6, s[24:25] nt
    s_add_u32 s24, s24, 3584
    s_addc_u32 s25, s25, 0
    global_load_dwordx4 v[156:159], v6, s[24:25] nt
    s_lshr_b32 s19, s15, 8
    s_and_b32 s19, s19, 0x3000
    s_xor_b32 s19, s19, s15
    s_lshr_b32 s81, s15, 5
    s_and_b32 s81, s81, 0x4000
    s_xor_b32 s19, s19, s81
    s_lshr_b32 s81, s15, 12
    s_and_b32 s81, s81, 0x200
    s_xor_b32 s19, s19, s81
    s_add_u32 s24, s4, s19
    s_addc_u32 s25, s5, 0
    global_load_dwordx4 v[224:227], v1, s[24:25] offset:0 nt
    global_load_dwordx4 v[228:231], v1, s[24:25] offset:64 nt
    global_load_dwordx4 v[232:235], v1, s[24:25] offset:128 nt
    global_load_dwordx4 v[236:239], v1, s[24:25] offset:192 nt
    s_add_u32 s26, s6, s19
    s_addc_u32 s27, s7, 0
    global_load_dwordx4 v[240:243], v69, s[26:27] offset:0 nt
    global_load_dwordx4 v[244:247], v69, s[26:27] offset:1024 nt
    global_load_dwordx4 v[248:251], v69, s[26:27] offset:2048 nt
    global_load_dwordx4 v[252:255], v69, s[26:27] offset:3072 nt
    s_add_u32 s15, s15, 262144
    v_mul_u32_u24 v9, 16640, v9
    v_lshl_add_u32 v8, v8, 4, v9
    v_add_u32 v8, 13824, v8
    v_mul_u32_u24 v9, 640, v0
    s_lshl_b32 s16, s3, 4
    s_add_u32 s16, s16, 80384
    v_add_u32 v9, s16, v9
    s_waitcnt vmcnt(16)
    v_perm_b32 v192, v100, v96, s22
    v_perm_b32 v196, v100, v96, s23
    v_perm_b32 v200, v101, v97, s22
    v_perm_b32 v204, v101, v97, s23
    v_perm_b32 v208, v102, v98, s22
    v_perm_b32 v212, v102, v98, s23
    v_perm_b32 v216, v103, v99, s22
    v_perm_b32 v220, v103, v99, s23
    v_perm_b32 v193, v108, v104, s22
    v_perm_b32 v197, v108, v104, s23
    v_perm_b32 v201, v109, v105, s22
    v_perm_b32 v205, v109, v105, s23
    v_perm_b32 v209, v110, v106, s22
    v_perm_b32 v213, v110, v106, s23
    v_perm_b32 v217, v111, v107, s22
    v_perm_b32 v221, v111, v107, s23
    v_perm_b32 v194, v116, v112, s22
    v_perm_b32 v198, v116, v112, s23
    v_perm_b32 v202, v117, v113, s22
    v_perm_b32 v206, v117, v113, s23
    v_perm_b32 v210, v118, v114, s22
    v_perm_b32 v214, v118, v114, s23
    v_perm_b32 v218, v119, v115, s22
    v_perm_b32 v222, v119, v115, s23
    v_perm_b32 v195, v124, v120, s22
    v_perm_b32 v199, v124, v120, s23
    v_perm_b32 v203, v125, v121, s22
    v_perm_b32 v207, v125, v121, s23
    v_perm_b32 v211, v126, v122, s22
    v_perm_b32 v215, v126, v122, s23
    v_perm_b32 v219, v127, v123, s22
    v_perm_b32 v223, v127, v123, s23
    ds_write_b128 v8, v[192:195] offset:0
    ds_write_b128 v8, v[196:199] offset:2080
    ds_write_b128 v8, v[200:203] offset:4160
    ds_write_b128 v8, v[204:207] offset:6240
    ds_write_b128 v8, v[208:211] offset:8320
    ds_write_b128 v8, v[212:215] offset:10400
    ds_write_b128 v8, v[216:219] offset:12480
    ds_write_b128 v8, v[220:223] offset:14560
    s_waitcnt lgkmcnt(0)
    s_waitcnt vmcnt(8)
    v_perm_b32 v192, v132, v128, s22
    v_perm_b32 v196, v132, v128, s23
    v_perm_b32 v200, v133, v129, s22
    v_perm_b32 v204, v133, v129, s23
    v_perm_b32 v208, v134, v130, s22
    v_perm_b32 v212, v134, v130, s23
    v_perm_b32 v216, v135, v131, s22
    v_perm_b32 v220, v135, v131, s23
    v_perm_b32 v193, v140, v136, s22
    v_perm_b32 v197, v140, v136, s23
    v_perm_b32 v201, v141, v137, s22
    v_perm_b32 v205, v141, v137, s23
    v_perm_b32 v209, v142, v138, s22
    v_perm_b32 v213, v142, v138, s23
    v_perm_b32 v217, v143, v139, s22
    v_perm_b32 v221, v143, v139, s23
    v_perm_b32 v194, v148, v144, s22
    v_perm_b32 v198, v148, v144, s23
    v_perm_b32 v202, v149, v145, s22
    v_perm_b32 v206, v149, v145, s23
    v_perm_b32 v210, v150, v146, s22
    v_perm_b32 v214, v150, v146, s23
    v_perm_b32 v218, v151, v147, s22
    v_perm_b32 v222, v151, v147, s23
    v_perm_b32 v195, v156, v152, s22
    v_perm_b32 v199, v156, v152, s23
    v_perm_b32 v203, v157, v153, s22
    v_perm_b32 v207, v157, v153, s23
    v_perm_b32 v211, v158, v154, s22
    v_perm_b32 v215, v158, v154, s23
    v_perm_b32 v219, v159, v155, s22
    v_perm_b32 v223, v159, v155, s23
    ds_write_b128 v8, v[192:195] offset:1040
    ds_write_b128 v8, v[196:199] offset:3120
    ds_write_b128 v8, v[200:203] offset:5200
    ds_write_b128 v8, v[204:207] offset:7280
    ds_write_b128 v8, v[208:211] offset:9360
    ds_write_b128 v8, v[212:215] offset:11440
    ds_write_b128 v8, v[216:219] offset:13520
    ds_write_b128 v8, v[220:223] offset:15600
    s_waitcnt lgkmcnt(0)
L_HOLDB:
    s_mov_b32 s13, s82
    s_cmp_ge_u32 s76, 16
    s_cbranch_scc1 L_NOHOLD
    s_barrier
    s_branch L_NOHOLD
L_HELP:
    s_setprio 3
    v_min_u32 v2, 39, v0
    v_lshlrev_b32 v2, 2, v2
    ds_write_b32 v2, v4 offset:1024
    v_mov_b32 v200, 0
    v_mov_b32 v201, 0
    v_mov_b32 v202, 0
    v_mov_b32 v203, 0
    v_mov_b32 v204, 0
    v_mov_b32 v205, 0
    s_sub_u32 s18, s3, 4
    v_lshrrev_b32 v16, 3, v0
    s_lshl_b32 s14, s18, 3
    v_add_u32 v16, s14, v16
    v_and_b32 v17, 7, v0
    v_lshlrev_b32 v17, 4, v17
    v_lshlrev_b32 v18, 5, v16
    s_waitcnt lgkmcnt(0)
    s_add_u32 s14, s10, 2
    s_and_b32 s14, s14, 15
    s_bfe_u32 s15, s76, 0x10004
    s_lshl_b32 s15, s15, 3
    s_add_u32 s15, s15, s14
    s_add_u32 s15, s15, 32
    s_cmp_lt_u32 s14, 8
    s_cselect_b32 s77, s15, 0xff
    s_cmp_lt_u32 s76, 32
    s_cselect_b32 s77, s76, s77
    s_cmp_ge_u32 s76, 64
    s_cselect_b32 s77, s76, s77
    s_load_dword s20, s[8:9], 0
    s_cmp_lt_u32 s77, 48
    s_cbranch_scc1 L_MOD
    s_lshr_b32 s14, s76, 6
    s_cmp_eq_u32 s14, 1
    s_cbranch_scc1 L_QU
    s_barrier
    s_waitcnt lgkmcnt(0)
    s_add_u32 s20, s20, 1
    s_cmp_lg_u32 s18, 0
    s_cbranch_scc1 L_NORACE
    s_cmp_eq_u32 s76, 224
    s_cselect_b32 s15, 0, 0x2000
    s_cbranch_scc1 L_RACE
    s_cmp_lg_u32 s76, 248
    s_cbranch_scc1 L_NORACE
L_RACE:
    s_add_u32 s14, s15, 524288
    s_add_u32 s24, s8, s14
    s_addc_u32 s25, s9, 0
    s_mov_b32 s21, 4
    s_mov_b64 exec, 1
L_RACEL:
    s_atomic_add s16, s[24:25], 0 glc
    s_waitcnt lgkmcnt(0)
    s_atomic_add s16, s[24:25], 4096 glc
    s_waitcnt lgkmcnt(0)
    s_atomic_add s16, s[24:25], 16384 glc
    s_waitcnt lgkmcnt(0)
    s_atomic_add s16, s[24:25], 20480 glc
    s_waitcnt lgkmcnt(0)
    s_sub_u32 s21, s21, 1
    s_cmp_lg_u32 s21, 0
    s_cbranch_scc1 L_RACEL
    s_mov_b32 s16, s20
    s_atomic_swap s16, s[8:9], 36992 glc
    v_mov_b32 v28, s15
    v_mov_b32 v29, s20
    v_mov_b32 v27, 36864
    s_waitcnt lgkmcnt(0)
    s_cmp_lg_u32 s16, s20
    s_cselect_b64 exec, 1, 0
    global_store_dwordx2 v27, v[28:29], s[8:9] sc1
    s_mov_b64 exec, -1
    s_branch L_HELP2
L_NORACE:
    s_sleep 120
    s_sleep 80
    s_branch L_HELP2
L_MOD:
    global_load_dwordx4 v[24:27], v18, s[54:55]
    global_load_dwordx4 v[28:31], v18, s[54:55] offset:16
    global_load_dwordx4 v[32:35], v18, s[54:55] offset:1024
    global_load_dwordx4 v[36:39], v18, s[54:55] offset:1040
    s_mov_b32 s14, 98304
    v_mul_lo_u32 v19, v16, s14
    v_add_u32 v19, v19, v17
    s_and_b32 s14, s77, 63
    s_lshl_b32 s14, s14, 7
    s_add_u32 s24, s56, s14
    s_addc_u32 s25, s57, 0
    global_load_dwordx4 v[136:139], v19, s[24:25] nt
    s_add_u32 s24, s24, 6144
    s_addc_u32 s25, s25, 0
    global_load_dwordx4 v[140:143], v19, s[24:25] nt
    s_add_u32 s24, s24, 6144
    s_addc_u32 s25, s25, 0
    global_load_dwordx4 v[144:147], v19, s[24:25] nt
    s_add_u32 s24, s24, 6144
    s_addc_u32 s25, s25, 0
    global_load_dwordx4 v[148:151], v19, s[24:25] nt
    s_add_u32 s24, s24, 6144
    s_addc_u32 s25, s25, 0
    global_load_dwordx4 v[152:155], v19, s[24:25] nt
    s_add_u32 s24, s24, 6144
    s_addc_u32 s25, s25, 0
    global_load_dwordx4 v[156:159], v19, s[24:25] nt
    s_add_u32 s24, s24, 6144
    s_addc_u32 s25, s25, 0
    global_load_dwordx4 v[160:163], v19, s[24:25] nt
    s_add_u32 s24, s24, 6144
    s_addc_u32 s25, s25, 0
    global_load_dwordx4 v[164:167], v19, s[24:25] nt
    s_add_u32 s24, s24, 6144
    s_addc_u32 s25, s25, 0
    global_load_dwordx4 v[168:171], v19, s[24:25] nt
    s_add_u32 s24, s24, 6144
    s_addc_u32 s25, s25, 0
    global_load_dwordx4 v[172:175], v19, s[24:25] nt
    s_add_u32 s24, s24, 6144
    s_addc_u32 s25, s25, 0
    global_load_dwordx4 v[176:179], v19, s[24:25] nt
    s_add_u32 s24, s24, 6144
    s_addc_u32 s25, s25, 0
    global_load_dwordx4 v[180:183], v19, s[24:25] nt
    s_add_u32 s24, s24, 6144
    s_addc_u32 s25, s25, 0
    global_load_dwordx4 v[184:187], v19, s[24:25] nt
    s_add_u32 s24, s24, 6144
    s_addc_u32 s25, s25, 0
    global_load_dwordx4 v[188:191], v19, s[24:25] nt
    s_add_u32 s24, s24, 6144
    s_addc_u32 s25, s25, 0
    global_load_dwordx4 v[192:195], v19, s[24:25] nt
    s_add_u32 s24, s24, 6144
    s_addc_u32 s25, s25, 0
    global_load_dwordx4 v[196:199], v19, s[24:25] nt
    s_barrier
    v_bfe_u32 v20, v0, 3, 2
    v_lshlrev_b32 v20, 3, v20
    v_lshl_add_u32 v20, v17, 1, v20
    v_lshrrev_b32 v21, 5, v0
    s_lshl_b32 s14, s18, 9
    v_lshlrev_b32 v22, 3, v0
    v_add_u32 v23, s14, v22
    s_mov_b32 s16, 0xbfb8aa3b
    s_waitcnt vmcnt(16)
    s_waitcnt lgkmcnt(0)
    v_lshlrev_b32 v56, 16, v24
    v_and_b32 v57, 0xffff0000, v24
    v_lshlrev_b32 v58, 16, v25
    v_and_b32 v59, 0xffff0000, v25
    v_lshlrev_b32 v60, 16, v26
    v_and_b32 v61, 0xffff0000, v26
    v_lshlrev_b32 v62, 16, v27
    v_and_b32 v63, 0xffff0000, v27
    v_lshlrev_b32 v64, 16, v28
    v_and_b32 v65, 0xffff0000, v28
    v_lshlrev_b32 v66, 16, v29
    v_and_b32 v67, 0xffff0000, v29
    v_lshlrev_b32 v68, 16, v30
    v_and_b32 v69, 0xffff0000, v30
    v_lshlrev_b32 v70, 16, v31
    v_and_b32 v71, 0xffff0000, v31
    v_mul_f32 v72, s16, v56
    v_mul_f32 v73, s16, v57
    v_mul_f32 v74, s16, v58
    v_mul_f32 v75, s16, v59
    v_mul_f32 v76, s16, v60
    v_mul_f32 v77, s16, v61
    v_mul_f32 v78, s16, v62
    v_mul_f32 v79, s16, v63
    v_mul_f32 v80, s16, v64
    v_mul_f32 v81, s16, v65
    v_mul_f32 v82, s16, v66
    v_mul_f32 v83, s16, v67
    v_mul_f32 v84, s16, v68
    v_mul_f32 v85, s16, v69
    v_mul_f32 v86, s16, v70
    v_mul_f32 v87, s16, v71
    v_exp_f32 v72, v72
    v_exp_f32 v73, v73
    v_exp_f32 v74, v74
    v_exp_f32 v75, v75
    v_exp_f32 v76, v76
    v_exp_f32 v77, v77
    v_exp_f32 v78, v78
    v_exp_f32 v79, v79
    v_exp_f32 v80, v80
    v_exp_f32 v81, v81
    v_exp_f32 v82, v82
    v_exp_f32 v83, v83
    v_exp_f32 v84, v84
    v_exp_f32 v85, v85
    v_exp_f32 v86, v86
    v_exp_f32 v87, v87
    v_add_f32 v72, 1.0, v72
    v_add_f32 v73, 1.0, v73
    v_add_f32 v74, 1.0, v74
    v_add_f32 v75, 1.0, v75
    v_add_f32 v76, 1.0, v76
    v_add_f32 v77, 1.0, v77
    v_add_f32 v78, 1.0, v78
    v_add_f32 v79, 1.0, v79
    v_add_f32 v80, 1.0, v80
    v_add_f32 v81, 1.0, v81
    v_add_f32 v82, 1.0, v82
    v_add_f32 v83, 1.0, v83
    v_add_f32 v84, 1.0, v84
    v_add_f32 v85, 1.0, v85
    v_add_f32 v86, 1.0, v86
    v_add_f32 v87, 1.0, v87
    v_rcp_f32 v88, v72
    v_rcp_f32 v89, v73
    v_rcp_f32 v90, v74
    v_rcp_f32 v91, v75
    v_rcp_f32 v92, v76
    v_rcp_f32 v93, v77
    v_rcp_f32 v94, v78
    v_rcp_f32 v95, v79
    v_rcp_f32 v96, v80
    v_rcp_f32 v97, v81
    v_rcp_f32 v98, v82
    v_rcp_f32 v99, v83
    v_rcp_f32 v100, v84
    v_rcp_f32 v101, v85
    v_rcp_f32 v102, v86
    v_rcp_f32 v103, v87
    v_mul_f32 v104, v56, v88
    v_mul_f32 v105, v57, v89
    v_mul_f32 v106, v58, v90
    v_mul_f32 v107, v59, v91
    v_mul_f32 v108, v60, v92
    v_mul_f32 v109, v61, v93
    v_mul_f32 v110, v62, v94
    v_mul_f32 v111, v63, v95
    v_mul_f32 v112, v64, v96
    v_mul_f32 v113, v65, v97
    v_mul_f32 v114, v66, v98
    v_mul_f32 v115, v67, v99
    v_mul_f32 v116, v68, v100
    v_mul_f32 v117, v69, v101
    v_mul_f32 v118, v70, v102
    v_mul_f32 v119, v71, v103
    v_fma_f32 v56, -v104, v72, v56
    v_fma_f32 v57, -v105, v73, v57
    v_fma_f32 v58, -v106, v74, v58
    v_fma_f32 v59, -v107, v75, v59
    v_fma_f32 v60, -v108, v76, v60
    v_fma_f32 v61, -v109, v77, v61
    v_fma_f32 v62, -v110, v78, v62
    v_fma_f32 v63, -v111, v79, v63
    v_fma_f32 v64, -v112, v80, v64
    v_fma_f32 v65, -v113, v81, v65
    v_fma_f32 v66, -v114, v82, v66
    v_fma_f32 v67, -v115, v83, v67
    v_fma_f32 v68, -v116, v84, v68
    v_fma_f32 v69, -v117, v85, v69
    v_fma_f32 v70, -v118, v86, v70
    v_fma_f32 v71, -v119, v87, v71
    v_fma_f32 v56, v56, v88, v104
    v_fma_f32 v57, v57, v89, v105
    v_fma_f32 v58, v58, v90, v106
    v_fma_f32 v59, v59, v91, v107
    v_fma_f32 v60, v60, v92, v108
    v_fma_f32 v61, v61, v93, v109
    v_fma_f32 v62, v62, v94, v110
    v_fma_f32 v63, v63, v95, v111
    v_fma_f32 v64, v64, v96, v112
    v_fma_f32 v65, v65, v97, v113
    v_fma_f32 v66, v66, v98, v114
    v_fma_f32 v67, v67, v99, v115
    v_fma_f32 v68, v68, v100, v116
    v_fma_f32 v69, v69, v101, v117
    v_fma_f32 v70, v70, v102, v118
    v_fma_f32 v71, v71, v103, v119
    v_cvt_pk_bf16_f32 v24, v56, v57
    v_cvt_pk_bf16_f32 v25, v58, v59
    v_cvt_pk_bf16_f32 v26, v60, v61
    v_cvt_pk_bf16_f32 v27, v62, v63
    v_cvt_pk_bf16_f32 v28, v64, v65
    v_cvt_pk_bf16_f32 v29, v66, v67
    v_cvt_pk_bf16_f32 v30, v68, v69
    v_cvt_pk_bf16_f32 v31, v70, v71
    v_lshlrev_b32 v56, 16, v32
    v_and_b32 v57, 0xffff0000, v32
    v_lshlrev_b32 v58, 16, v33
    v_and_b32 v59, 0xffff0000, v33
    v_lshlrev_b32 v60, 16, v34
    v_and_b32 v61, 0xffff0000, v34
    v_lshlrev_b32 v62, 16, v35
    v_and_b32 v63, 0xffff0000, v35
    v_lshlrev_b32 v64, 16, v36
    v_and_b32 v65, 0xffff0000, v36
    v_lshlrev_b32 v66, 16, v37
    v_and_b32 v67, 0xffff0000, v37
    v_lshlrev_b32 v68, 16, v38
    v_and_b32 v69, 0xffff0000, v38
    v_lshlrev_b32 v70, 16, v39
    v_and_b32 v71, 0xffff0000, v39
    v_mul_f32 v72, s16, v56
    v_mul_f32 v73, s16, v57
    v_mul_f32 v74, s16, v58
    v_mul_f32 v75, s16, v59
    v_mul_f32 v76, s16, v60
    v_mul_f32 v77, s16, v61
    v_mul_f32 v78, s16, v62
    v_mul_f32 v79, s16, v63
    v_mul_f32 v80, s16, v64
    v_mul_f32 v81, s16, v65
    v_mul_f32 v82, s16, v66
    v_mul_f32 v83, s16, v67
    v_mul_f32 v84, s16, v68
    v_mul_f32 v85, s16, v69
    v_mul_f32 v86, s16, v70
    v_mul_f32 v87, s16, v71
    v_exp_f32 v72, v72
    v_exp_f32 v73, v73
    v_exp_f32 v74, v74
    v_exp_f32 v75, v75
    v_exp_f32 v76, v76
    v_exp_f32 v77, v77
    v_exp_f32 v78, v78
    v_exp_f32 v79, v79
    v_exp_f32 v80, v80
    v_exp_f32 v81, v81
    v_exp_f32 v82, v82
    v_exp_f32 v83, v83
    v_exp_f32 v84, v84
    v_exp_f32 v85, v85
    v_exp_f32 v86, v86
    v_exp_f32 v87, v87
    v_add_f32 v72, 1.0, v72
    v_add_f32 v73, 1.0, v73
    v_add_f32 v74, 1.0, v74
    v_add_f32 v75, 1.0, v75
    v_add_f32 v76, 1.0, v76
    v_add_f32 v77, 1.0, v77
    v_add_f32 v78, 1.0, v78
    v_add_f32 v79, 1.0, v79
    v_add_f32 v80, 1.0, v80
    v_add_f32 v81, 1.0, v81
    v_add_f32 v82, 1.0, v82
    v_add_f32 v83, 1.0, v83
    v_add_f32 v84, 1.0, v84
    v_add_f32 v85, 1.0, v85
    v_add_f32 v86, 1.0, v86
    v_add_f32 v87, 1.0, v87
    v_rcp_f32 v88, v72
    v_rcp_f32 v89, v73
    v_rcp_f32 v90, v74
    v_rcp_f32 v91, v75
    v_rcp_f32 v92, v76
    v_rcp_f32 v93, v77
    v_rcp_f32 v94, v78
    v_rcp_f32 v95, v79
    v_rcp_f32 v96, v80
    v_rcp_f32 v97, v81
    v_rcp_f32 v98, v82
    v_rcp_f32 v99, v83
    v_rcp_f32 v100, v84
    v_rcp_f32 v101, v85
    v_rcp_f32 v102, v86
    v_rcp_f32 v103, v87
    v_mul_f32 v104, v56, v88
    v_mul_f32 v105, v57, v89
    v_mul_f32 v106, v58, v90
    v_mul_f32 v107, v59, v91
    v_mul_f32 v108, v60, v92
    v_mul_f32 v109, v61, v93
    v_mul_f32 v110, v62, v94
    v_mul_f32 v111, v63, v95
    v_mul_f32 v112, v64, v96
    v_mul_f32 v113, v65, v97
    v_mul_f32 v114, v66, v98
    v_mul_f32 v115, v67, v99
    v_mul_f32 v116, v68, v100
    v_mul_f32 v117, v69, v101
    v_mul_f32 v118, v70, v102
    v_mul_f32 v119, v71, v103
    v_fma_f32 v56, -v104, v72, v56
    v_fma_f32 v57, -v105, v73, v57
    v_fma_f32 v58, -v106, v74, v58
    v_fma_f32 v59, -v107, v75, v59
    v_fma_f32 v60, -v108, v76, v60
    v_fma_f32 v61, -v109, v77, v61
    v_fma_f32 v62, -v110, v78, v62
    v_fma_f32 v63, -v111, v79, v63
    v_fma_f32 v64, -v112, v80, v64
    v_fma_f32 v65, -v113, v81, v65
    v_fma_f32 v66, -v114, v82, v66
    v_fma_f32 v67, -v115, v83, v67
    v_fma_f32 v68, -v116, v84, v68
    v_fma_f32 v69, -v117, v85, v69
    v_fma_f32 v70, -v118, v86, v70
    v_fma_f32 v71, -v119, v87, v71
    v_fma_f32 v56, v56, v88, v104
    v_fma_f32 v57, v57, v89, v105
    v_fma_f32 v58, v58, v90, v106
    v_fma_f32 v59, v59, v91, v107
    v_fma_f32 v60, v60, v92, v108
    v_fma_f32 v61, v61, v93, v109
    v_fma_f32 v62, v62, v94, v110
    v_fma_f32 v63, v63, v95, v111
    v_fma_f32 v64, v64, v96, v112
    v_fma_f32 v65, v65, v97, v113
    v_fma_f32 v66, v66, v98, v114
    v_fma_f32 v67, v67, v99, v115
    v_fma_f32 v68, v68, v100, v116
    v_fma_f32 v69, v69, v101, v117
    v_fma_f32 v70, v70, v102, v118
    v_fma_f32 v71, v71, v103, v119
    v_cvt_pk_bf16_f32 v32, v56, v57
    v_cvt_pk_bf16_f32 v33, v58, v59
    v_cvt_pk_bf16_f32 v34, v60, v61
    v_cvt_pk_bf16_f32 v35, v62, v63
    v_cvt_pk_bf16_f32 v36, v64, v65
    v_cvt_pk_bf16_f32 v37, v66, v67
    v_cvt_pk_bf16_f32 v38, v68, v69
    v_cvt_pk_bf16_f32 v39, v70, v71
    s_add_u32 s20, s20, 1
    s_waitcnt vmcnt(8)
    v_perm_b32 v128, v140, v136, s22
    v_perm_b32 v129, v140, v136, s23
    v_perm_b32 v130, v141, v137, s22
    v_perm_b32 v131, v141, v137, s23
    v_perm_b32 v132, v142, v138, s22
    v_perm_b32 v133, v142, v138, s23
    v_perm_b32 v134, v143, v139, s22
    v_perm_b32 v135, v143, v139, s23
    v_perm_b32 v136, v148, v144, s22
    v_perm_b32 v137, v148, v144, s23
    v_perm_b32 v138, v149, v145, s22
    v_perm_b32 v139, v149, v145, s23
    v_perm_b32 v140, v150, v146, s22
    v_perm_b32 v141, v150, v146, s23
    v_perm_b32 v142, v151, v147, s22
    v_perm_b32 v143, v151, v147, s23
    v_perm_b32 v144, v156, v152, s22
    v_perm_b32 v145, v156, v152, s23
    v_perm_b32 v146, v157, v153, s22
    v_perm_b32 v147, v157, v153, s23
    v_perm_b32 v148, v158, v154, s22
    v_perm_b32 v149, v158, v154, s23
    v_perm_b32 v150, v159, v155, s22
    v_perm_b32 v151, v159, v155, s23
    v_perm_b32 v152, v164, v160, s22
    v_perm_b32 v153, v164, v160, s23
    v_perm_b32 v154, v165, v161, s22
    v_perm_b32 v155, v165, v161, s23
    v_perm_b32 v156, v166, v162, s22
    v_perm_b32 v157, v166, v162, s23
    v_perm_b32 v158, v167, v163, s22
    v_perm_b32 v159, v167, v163, s23
    s_waitcnt vmcnt(0)
    s_cmp_ge_u32 s76, 16
    s_cbranch_scc1 L_NOHOLD2
    s_barrier
L_NOHOLD2:
    v_perm_b32 v160, v172, v168, s22
    v_perm_b32 v161, v172, v168, s23
    v_perm_b32 v162, v173, v169, s22
    v_perm_b32 v163, v173, v169, s23
    v_perm_b32 v164, v174, v170, s22
    v_perm_b32 v165, v174, v170, s23
    v_perm_b32 v166, v175, v171, s22
    v_perm_b32 v167, v175, v171, s23
    v_perm_b32 v168, v180, v176, s22
    v_perm_b32 v169, v180, v176, s23
    v_perm_b32 v170, v181, v177, s22
    v_perm_b32 v171, v181, v177, s23
    v_perm_b32 v172, v182, v178, s22
    v_perm_b32 v173, v182, v178, s23
    v_perm_b32 v174, v183, v179, s22
    v_perm_b32 v175, v183, v179, s23
    v_perm_b32 v176, v188, v184, s22
    v_perm_b32 v177, v188, v184, s23
    v_perm_b32 v178, v189, v185, s22
    v_perm_b32 v179, v189, v185, s23
    v_perm_b32 v180, v190, v186, s22
    v_perm_b32 v181, v190, v186, s23
    v_perm_b32 v182, v191, v187, s22
    v_perm_b32 v183, v191, v187, s23
    v_perm_b32 v184, v196, v192, s22
    v_perm_b32 v185, v196, v192, s23
    v_perm_b32 v186, v197, v193, s22
    v_perm_b32 v187, v197, v193, s23
    v_perm_b32 v188, v198, v194, s22
    v_perm_b32 v189, v198, v194, s23
    v_perm_b32 v190, v199, v195, s22
    v_perm_b32 v191, v199, v195, s23
    s_lshr_b32 s15, s77, 3
    s_lshl_b32 s15, s15, 12
    s_and_b32 s14, s77, 7
    s_lshl_b32 s14, s14, 8
    s_add_u32 s15, s15, s14
    s_cmp_lt_u32 s76, 16
    s_cselect_b32 s14, 155648, 0
    s_add_u32 s15, s15, s14
    s_add_u32 s15, s15, 40960
    v_dot2_f32_bf16 v56, v128, v24, 0
    v_dot2_f32_bf16 v57, v129, v24, 0
    v_dot2_f32_bf16 v58, v130, v24, 0
    v_dot2_f32_bf16 v59, v131, v24, 0
    v_dot2_f32_bf16 v60, v132, v24, 0
    v_dot2_f32_bf16 v61, v133, v24, 0
    v_dot2_f32_bf16 v62, v134, v24, 0
    v_dot2_f32_bf16 v63, v135, v24, 0
    v_dot2_f32_bf16 v64, v128, v32, 0
    v_dot2_f32_bf16 v65, v129, v32, 0
    v_dot2_f32_bf16 v66, v130, v32, 0
    v_dot2_f32_bf16 v67, v131, v32, 0
    v_dot2_f32_bf16 v68, v132, v32, 0
    v_dot2_f32_bf16 v69, v133, v32, 0
    v_dot2_f32_bf16 v70, v134, v32, 0
    v_dot2_f32_bf16 v71, v135, v32, 0
    v_dot2_f32_bf16 v56, v136, v25, v56
    v_dot2_f32_bf16 v57, v137, v25, v57
    v_dot2_f32_bf16 v58, v138, v25, v58
    v_dot2_f32_bf16 v59, v139, v25, v59
    v_dot2_f32_bf16 v60, v140, v25, v60
    v_dot2_f32_bf16 v61, v141, v25, v61
    v_dot2_f32_bf16 v62, v142, v25, v62
    v_dot2_f32_bf16 v63, v143, v25, v63
    v_dot2_f32_bf16 v64, v136, v33, v64
    v_dot2_f32_bf16 v65, v137, v33, v65
    v_dot2_f32_bf16 v66, v138, v33, v66
    v_dot2_f32_bf16 v67, v139, v33, v67
    v_dot2_f32_bf16 v68, v140, v33, v68
    v_dot2_f32_bf16 v69, v141, v33, v69
    v_dot2_f32_bf16 v70, v142, v33, v70
    v_dot2_f32_bf16 v71, v143, v33, v71
    v_dot2_f32_bf16 v56, v144, v26, v56
    v_dot2_f32_bf16 v57, v145, v26, v57
    v_dot2_f32_bf16 v58, v146, v26, v58
    v_dot2_f32_bf16 v59, v147, v26, v59
    v_dot2_f32_bf16 v60, v148, v26, v60
    v_dot2_f32_bf16 v61, v149, v26, v61
    v_dot2_f32_bf16 v62, v150, v26, v62
    v_dot2_f32_bf16 v63, v151, v26, v63
    v_dot2_f32_bf16 v64, v144, v34, v64
    v_dot2_f32_bf16 v65, v145, v34, v65
    v_dot2_f32_bf16 v66, v146, v34, v66
    v_dot2_f32_bf16 v67, v147, v34, v67
    v_dot2_f32_bf16 v68, v148, v34, v68
    v_dot2_f32_bf16 v69, v149, v34, v69
    v_dot2_f32_bf16 v70, v150, v34, v70
    v_dot2_f32_bf16 v71, v151, v34, v71
    v_dot2_f32_bf16 v56, v152, v27, v56
    v_dot2_f32_bf16 v57, v153, v27, v57
    v_dot2_f32_bf16 v58, v154, v27, v58
    v_dot2_f32_bf16 v59, v155, v27, v59
    v_dot2_f32_bf16 v60, v156, v27, v60
    v_dot2_f32_bf16 v61, v157, v27, v61
    v_dot2_f32_bf16 v62, v158, v27, v62
    v_dot2_f32_bf16 v63, v159, v27, v63
    v_dot2_f32_bf16 v64, v152, v35, v64
    v_dot2_f32_bf16 v65, v153, v35, v65
    v_dot2_f32_bf16 v66, v154, v35, v66
    v_dot2_f32_bf16 v67, v155, v35, v67
    v_dot2_f32_bf16 v68, v156, v35, v68
    v_dot2_f32_bf16 v69, v157, v35, v69
    v_dot2_f32_bf16 v70, v158, v35, v70
    v_dot2_f32_bf16 v71, v159, v35, v71
    v_dot2_f32_bf16 v56, v160, v28, v56
    v_dot2_f32_bf16 v57, v161, v28, v57
    v_dot2_f32_bf16 v58, v162, v28, v58
    v_dot2_f32_bf16 v59, v163, v28, v59
    v_dot2_f32_bf16 v60, v164, v28, v60
    v_dot2_f32_bf16 v61, v165, v28, v61
    v_dot2_f32_bf16 v62, v166, v28, v62
    v_dot2_f32_bf16 v63, v167, v28, v63
    v_dot2_f32_bf16 v64, v160, v36, v64
    v_dot2_f32_bf16 v65, v161, v36, v65
    v_dot2_f32_bf16 v66, v162, v36, v66
    v_dot2_f32_bf16 v67, v163, v36, v67
    v_dot2_f32_bf16 v68, v164, v36, v68
    v_dot2_f32_bf16 v69, v165, v36, v69
    v_dot2_f32_bf16 v70, v166, v36, v70
    v_dot2_f32_bf16 v71, v167, v36, v71
    v_dot2_f32_bf16 v56, v168, v29, v56
    v_dot2_f32_bf16 v57, v169, v29, v57
    v_dot2_f32_bf16 v58, v170, v29, v58
    v_dot2_f32_bf16 v59, v171, v29, v59
    v_dot2_f32_bf16 v60, v172, v29, v60
    v_dot2_f32_bf16 v61, v173, v29, v61
    v_dot2_f32_bf16 v62, v174, v29, v62
    v_dot2_f32_bf16 v63, v175, v29, v63
    v_dot2_f32_bf16 v64, v168, v37, v64
    v_dot2_f32_bf16 v65, v169, v37, v65
    v_dot2_f32_bf16 v66, v170, v37, v66
    v_dot2_f32_bf16 v67, v171, v37, v67
    v_dot2_f32_bf16 v68, v172, v37, v68
    v_dot2_f32_bf16 v69, v173, v37, v69
    v_dot2_f32_bf16 v70, v174, v37, v70
    v_dot2_f32_bf16 v71, v175, v37, v71
    v_dot2_f32_bf16 v56, v176, v30, v56
    v_dot2_f32_bf16 v57, v177, v30, v57
    v_dot2_f32_bf16 v58, v178, v30, v58
    v_dot2_f32_bf16 v59, v179, v30, v59
    v_dot2_f32_bf16 v60, v180, v30, v60
    v_dot2_f32_bf16 v61, v181, v30, v61
    v_dot2_f32_bf16 v62, v182, v30, v62
    v_dot2_f32_bf16 v63, v183, v30, v63
    v_dot2_f32_bf16 v64, v176, v38, v64
    v_dot2_f32_bf16 v65, v177, v38, v65
    v_dot2_f32_bf16 v66, v178, v38, v66
    v_dot2_f32_bf16 v67, v179, v38, v67
    v_dot2_f32_bf16 v68, v180, v38, v68
    v_dot2_f32_bf16 v69, v181, v38, v69
    v_dot2_f32_bf16 v70, v182, v38, v70
    v_dot2_f32_bf16 v71, v183, v38, v71
    v_dot2_f32_bf16 v56, v184, v31, v56
    v_dot2_f32_bf16 v57, v185, v31, v57
    v_dot2_f32_bf16 v58, v186, v31, v58
    v_dot2_f32_bf16 v59, v187, v31, v59
    v_dot2_f32_bf16 v60, v188, v31, v60
    v_dot2_f32_bf16 v61, v189, v31, v61
    v_dot2_f32_bf16 v62, v190, v31, v62
    v_dot2_f32_bf16 v63, v191, v31, v63
    v_dot2_f32_bf16 v64, v184, v39, v64
    v_dot2_f32_bf16 v65, v185, v39, v65
    v_dot2_f32_bf16 v66, v186, v39, v66
    v_dot2_f32_bf16 v67, v187, v39, v67
    v_dot2_f32_bf16 v68, v188, v39, v68
    v_dot2_f32_bf16 v69, v189, v39, v69
    v_dot2_f32_bf16 v70, v190, v39, v70
    v_dot2_f32_bf16 v71, v191, v39, v71
    v_permlane32_swap_b32 v56, v64
    v_permlane32_swap_b32 v57, v65
    v_permlane32_swap_b32 v58, v66
    v_permlane32_swap_b32 v59, v67
    v_permlane32_swap_b32 v60, v68
    v_permlane32_swap_b32 v61, v69
    v_permlane32_swap_b32 v62, v70
    v_permlane32_swap_b32 v63, v71
    v_add_f32 v56, v56, v64
    v_add_f32 v57, v57, v65
    v_add_f32 v58, v58, v66
    v_add_f32 v59, v59, v67
    v_add_f32 v60, v60, v68
    v_add_f32 v61, v61, v69
    v_add_f32 v62, v62, v70
    v_add_f32 v63, v63, v71
    v_permlane16_swap_b32 v56, v60
    v_permlane16_swap_b32 v57, v61
    v_permlane16_swap_b32 v58, v62
    v_permlane16_swap_b32 v59, v63
    v_add_f32 v56, v56, v60
    v_add_f32 v57, v57, v61
    v_add_f32 v58, v58, v62
    v_add_f32 v59, v59, v63
    v_add_f32_dpp v56, v56, v56 row_ror:8 row_mask:0xf bank_mask:0x3
    v_add_f32_dpp v57, v57, v57 row_ror:8 row_mask:0xf bank_mask:0x3
    s_nop 0
    v_add_f32_dpp v56, v58, v58 row_ror:8 row_mask:0xf bank_mask:0xc
    v_add_f32_dpp v57, v59, v59 row_ror:8 row_mask:0xf bank_mask:0xc
    ds_write_b64 v23, v[56:57] offset:11776
    s_waitcnt lgkmcnt(0)
    s_lshl_b32 s14, s18, 2
    v_mov_b32 v2, s14
    v_mov_b32 v3, 1
    ds_write_b32 v2, v3 offset:1040
    s_cmp_lg_u32 s18, 0
    s_cbranch_scc1 L_HELP2
    v_lshlrev_b32 v72, 11, v21
    v_add_u32 v72, v72, v20
    v_add_u32 v72, s15, v72
    s_mov_b32 s21, 1600000
    v_mov_b32 v68, 0
FWM_3:
    ds_read_b128 v[64:67], v68 offset:1040
    s_waitcnt lgkmcnt(0)
    v_and_b32 v64, v64, v65
    v_bitop3_b32 v64, v64, v66, v67 bitop3:0x80
    v_cmp_ne_u32 vcc, 1, v64
    s_nop 0
    s_cbranch_vccz FDM_4
    s_sub_u32 s21, s21, 1
    s_cbranch_scc0 FWM_3
FDM_4:
    ds_read_b64 v[56:57], v22 offset:11776
    ds_read_b64 v[58:59], v22 offset:12288
    ds_read_b64 v[60:61], v22 offset:12800
    ds_read_b64 v[62:63], v22 offset:13312
    s_waitcnt lgkmcnt(0)
    v_pk_add_f32 v[56:57], v[56:57], v[58:59]
    v_pk_add_f32 v[60:61], v[60:61], v[62:63]
    v_pk_add_f32 v[56:57], v[56:57], v[60:61]
    v_cvt_pk_bf16_f32 v56, v56, v57
    v_mov_b32 v57, s20
    global_store_dwordx2 v72, v[56:57], s[8:9] sc1
    s_cmp_ge_u32 s76, 16
    s_cbranch_scc1 L_HELP2
    v_add_u32 v72, 0x2000, v72
    global_store_dwordx2 v72, v[56:57], s[8:9] sc1
    v_add_u32 v72, 0x2000, v72
    global_store_dwordx2 v72, v[56:57], s[8:9] sc1
    v_add_u32 v72, 0x2000, v72
    global_store_dwordx2 v72, v[56:57], s[8:9] sc1
    s_branch L_HELP2
L_QU:
    s_bfe_u32 s14, s76, 0x30003
    s_lshl_b32 s14, s14, 15
    s_and_b32 s15, s76, 7
    s_lshl_b32 s15, s15, 12
    s_add_u32 s14, s14, s15
    s_lshl_b32 s15, s18, 10
    s_add_u32 s14, s14, s15
    s_add_u32 s14, s14, 1048576
    v_add_u32 v28, s14, v5
    v_add_u32 v29, 0x40000, v28
    v_mov_b32 v100, -1
    v_mov_b32 v101, -1
    v_mov_b32 v102, -1
    v_mov_b32 v103, -1
    global_store_dwordx4 v28, v[100:103], s[8:9] sc1
    global_store_dwordx4 v29, v[100:103], s[8:9] sc1
    s_bfe_u32 s14, s76, 0x30003
    s_lshl_b32 s14, s14, 2
    s_add_u32 s14, s14, s18
    s_and_b32 s15, s76, 7
    s_lshl_b32 s15, s15, 7
    s_add_u32 s14, s14, s15
    s_lshl_b32 s14, s14, 7
    s_add_u32 s14, s14, 1572864
    v_bfe_u32 v29, v0, 3, 2
    v_lshlrev_b32 v29, 12, v29
    v_and_b32 v31, 0x70, v5
    v_add3_u32 v29, v29, v31, s14
    s_mov_b32 exec_hi, 0
    global_store_dwordx4 v29, v[100:103], s[8:9] sc1
    s_mov_b32 exec_hi, -1
    s_and_b32 s14, s3, 1
    s_lshl_b32 s14, s14, 10
    s_add_u32 s24, s40, s14
    s_addc_u32 s25, s41, 0
    v_lshlrev_b32 v30, 3, v0
    global_load_dwordx2 v[24:25], v30, s[24:25]
    global_load_dwordx2 v[26:27], v30, s[24:25] offset:512
    s_mov_b32 s14, 131072
    v_mul_lo_u32 v19, v16, s14
    v_add_u32 v19, v19, v17
    s_and_b32 s14, s77, 63
    s_lshl_b32 s14, s14, 7
    s_add_u32 s24, s44, s14
    s_addc_u32 s25, s45, 0
    global_load_dwordx4 v[136:139], v19, s[24:25] nt
    s_add_u32 s24, s24, 8192
    s_addc_u32 s25, s25, 0
    global_load_dwordx4 v[140:143], v19, s[24:25] nt
    s_add_u32 s24, s24, 8192
    s_addc_u32 s25, s25, 0
    global_load_dwordx4 v[144:147], v19, s[24:25] nt
    s_add_u32 s24, s24, 8192
    s_addc_u32 s25, s25, 0
    global_load_dwordx4 v[148:151], v19, s[24:25] nt
    s_add_u32 s24, s24, 8192
    s_addc_u32 s25, s25, 0
    global_load_dwordx4 v[152:155], v19, s[24:25] nt
    s_add_u32 s24, s24, 8192
    s_addc_u32 s25, s25, 0
    global_load_dwordx4 v[156:159], v19, s[24:25] nt
    s_add_u32 s24, s24, 8192
    s_addc_u32 s25, s25, 0
    global_load_dwordx4 v[160:163], v19, s[24:25] nt
    s_add_u32 s24, s24, 8192
    s_addc_u32 s25, s25, 0
    global_load_dwordx4 v[164:167], v19, s[24:25] nt
    s_add_u32 s24, s24, 8192
    s_addc_u32 s25, s25, 0
    global_load_dwordx4 v[168:171], v19, s[24:25] nt
    s_add_u32 s24, s24, 8192
    s_addc_u32 s25, s25, 0
    global_load_dwordx4 v[172:175], v19, s[24:25] nt
    s_add_u32 s24, s24, 8192
    s_addc_u32 s25, s25, 0
    global_load_dwordx4 v[176:179], v19, s[24:25] nt
    s_add_u32 s24, s24, 8192
    s_addc_u32 s25, s25, 0
    global_load_dwordx4 v[180:183], v19, s[24:25] nt
    s_add_u32 s24, s24, 8192
    s_addc_u32 s25, s25, 0
    global_load_dwordx4 v[184:187], v19, s[24:25] nt
    s_add_u32 s24, s24, 8192
    s_addc_u32 s25, s25, 0
    global_load_dwordx4 v[188:191], v19, s[24:25] nt
    s_add_u32 s24, s24, 8192
    s_addc_u32 s25, s25, 0
    global_load_dwordx4 v[192:195], v19, s[24:25] nt
    s_add_u32 s24, s24, 8192
    s_addc_u32 s25, s25, 0
    global_load_dwordx4 v[196:199], v19, s[24:25] nt
    s_barrier
    v_bfe_u32 v20, v0, 3, 2
    v_lshlrev_b32 v20, 3, v20
    v_lshl_add_u32 v20, v17, 1, v20
    v_lshrrev_b32 v21, 5, v0
    s_lshl_b32 s14, s18, 9
    v_lshlrev_b32 v22, 3, v0
    v_add_u32 v23, s14, v22
    s_and_b32 s14, s76, 7
    s_or_b32 s14, s14, s18
    s_cmp_lg_u32 s14, 0
    s_cbranch_scc1 L_NOZ
    s_bfe_u32 s14, s76, 0x30003
    s_lshl_b32 s14, s14, 12
    s_add_u32 s14, s14, 393216
    v_and_b32 v28, 31, v0
    v_lshlrev_b32 v28, 7, v28
    v_lshrrev_b32 v29, 5, v0
    v_lshl_add_u32 v28, v29, 15, v28
    v_add_u32 v28, s14, v28
    global_store_dword v28, v4, s[8:9] sc1
L_NOZ:
    s_waitcnt vmcnt(16)
    s_waitcnt lgkmcnt(0)
    s_add_u32 s20, s20, 1
    v_lshlrev_b32 v32, 16, v24
    v_and_b32 v33, 0xffff0000, v24
    v_lshlrev_b32 v34, 16, v25
    v_and_b32 v35, 0xffff0000, v25
    v_lshlrev_b32 v36, 16, v26
    v_and_b32 v37, 0xffff0000, v26
    v_lshlrev_b32 v38, 16, v27
    v_and_b32 v39, 0xffff0000, v27
    v_readfirstlane_b32 s30, v32
    s_nop 1
    v_subrev_f32 v42, s30, v32
    v_subrev_f32 v43, s30, v33
    v_subrev_f32 v44, s30, v34
    v_subrev_f32 v45, s30, v35
    v_subrev_f32 v46, s30, v36
    v_subrev_f32 v47, s30, v37
    v_subrev_f32 v48, s30, v38
    v_subrev_f32 v49, s30, v39
    v_add_f32 v40, v42, v43
    v_mul_f32 v41, v42, v42
    v_fmac_f32 v41, v43, v43
    v_add_f32 v40, v40, v44
    v_fmac_f32 v41, v44, v44
    v_add_f32 v40, v40, v45
    v_fmac_f32 v41, v45, v45
    v_add_f32 v40, v40, v46
    v_fmac_f32 v41, v46, v46
    v_add_f32 v40, v40, v47
    v_fmac_f32 v41, v47, v47
    v_add_f32 v40, v40, v48
    v_fmac_f32 v41, v48, v48
    v_add_f32 v40, v40, v49
    v_fmac_f32 v41, v49, v49
    s_nop 0
    v_add_f32_dpp v40, v40, v40 quad_perm:[1,0,3,2] row_mask:0xf bank_mask:0xf
    v_add_f32_dpp v41, v41, v41 quad_perm:[1,0,3,2] row_mask:0xf bank_mask:0xf
    s_nop 0
    v_add_f32_dpp v40, v40, v40 quad_perm:[2,3,0,1] row_mask:0xf bank_mask:0xf
    v_add_f32_dpp v41, v41, v41 quad_perm:[2,3,0,1] row_mask:0xf bank_mask:0xf
    s_nop 0
    v_add_f32_dpp v40, v40, v40 row_half_mirror row_mask:0xf bank_mask:0xf
    v_add_f32_dpp v41, v41, v41 row_half_mirror row_mask:0xf bank_mask:0xf
    s_nop 0
    v_add_f32_dpp v40, v40, v40 row_mirror row_mask:0xf bank_mask:0xf
    v_add_f32_dpp v41, v41, v41 row_mirror row_mask:0xf bank_mask:0xf
    s_nop 1
    v_permlane16_swap_b32 v40, v41
    v_add_f32 v40, v40, v41
    v_mov_b32 v41, v40
    s_nop 1
    v_permlane32_swap_b32 v40, v41
    v_add_f32 v40, v40, v41
    s_mov_b32 s33, 0x3b000000
    v_mul_f32 v40, s33, v40
    s_nop 0
    v_readlane_b32 s31, v40, 0
    v_readlane_b32 s32, v40, 16
    s_nop 0
    v_mov_b32 v42, s31
    v_mov_b32 v43, s32
    v_add_f32 v40, s30, v42
    v_fma_f32 v41, -v42, v42, v43
    v_max_f32 v41, 0, v41
    v_cvt_pk_bf16_f32 v42, v40, v41
    v_lshlrev_b32 v40, 16, v42
    v_and_b32 v41, 0xffff0000, v42
    v_add_f32 v41, 0x3727c5ac, v41
    v_cvt_pk_bf16_f32 v41, v41, v41
    v_and_b32 v41, 0xffff0000, v41
    v_sqrt_f32 v41, v41
    s_nop 0
    v_cvt_pk_bf16_f32 v50, v41, v41
    v_and_b32 v50, 0xffff0000, v50
    v_rcp_f32 v41, v50
    v_sub_f32 v32, v32, v40
    v_sub_f32 v33, v33, v40
    v_sub_f32 v34, v34, v40
    v_sub_f32 v35, v35, v40
    v_sub_f32 v36, v36, v40
    v_sub_f32 v37, v37, v40
    v_sub_f32 v38, v38, v40
    v_sub_f32 v39, v39, v40
    v_cvt_pk_bf16_f32 v42, v32, v33
    v_lshlrev_b32 v32, 16, v42
    v_and_b32 v33, 0xffff0000, v42
    v_cvt_pk_bf16_f32 v43, v34, v35
    v_lshlrev_b32 v34, 16, v43
    v_and_b32 v35, 0xffff0000, v43
    v_cvt_pk_bf16_f32 v44, v36, v37
    v_lshlrev_b32 v36, 16, v44
    v_and_b32 v37, 0xffff0000, v44
    v_cvt_pk_bf16_f32 v45, v38, v39
    v_lshlrev_b32 v38, 16, v45
    v_and_b32 v39, 0xffff0000, v45
    v_mul_f32 v42, v32, v41
    v_mul_f32 v43, v33, v41
    v_mul_f32 v44, v34, v41
    v_mul_f32 v45, v35, v41
    v_mul_f32 v46, v36, v41
    v_mul_f32 v47, v37, v41
    v_mul_f32 v48, v38, v41
    v_mul_f32 v49, v39, v41
    v_fma_f32 v32, -v42, v50, v32
    v_fma_f32 v33, -v43, v50, v33
    v_fma_f32 v34, -v44, v50, v34
    v_fma_f32 v35, -v45, v50, v35
    v_fma_f32 v36, -v46, v50, v36
    v_fma_f32 v37, -v47, v50, v37
    v_fma_f32 v38, -v48, v50, v38
    v_fma_f32 v39, -v49, v50, v39
    v_fma_f32 v32, v32, v41, v42
    v_fma_f32 v33, v33, v41, v43
    v_fma_f32 v34, v34, v41, v44
    v_fma_f32 v35, v35, v41, v45
    v_fma_f32 v36, v36, v41, v46
    v_fma_f32 v37, v37, v41, v47
    v_fma_f32 v38, v38, v41, v48
    v_fma_f32 v39, v39, v41, v49
    v_cvt_pk_bf16_f32 v42, v32, v33
    v_lshlrev_b32 v32, 16, v42
    v_and_b32 v33, 0xffff0000, v42
    v_cvt_pk_bf16_f32 v43, v34, v35
    v_lshlrev_b32 v34, 16, v43
    v_and_b32 v35, 0xffff0000, v43
    v_cvt_pk_bf16_f32 v44, v36, v37
    v_lshlrev_b32 v36, 16, v44
    v_and_b32 v37, 0xffff0000, v44
    v_cvt_pk_bf16_f32 v45, v38, v39
    v_lshlrev_b32 v38, 16, v45
    v_and_b32 v39, 0xffff0000, v45
    s_waitcnt vmcnt(0)
    v_perm_b32 v128, v140, v136, s22
    v_perm_b32 v129, v140, v136, s23
    v_perm_b32 v130, v141, v137, s22
    v_perm_b32 v131, v141, v137, s23
    v_perm_b32 v132, v142, v138, s22
    v_perm_b32 v133, v142, v138, s23
    v_perm_b32 v134, v143, v139, s22
    v_perm_b32 v135, v143, v139, s23
    v_perm_b32 v136, v148, v144, s22
    v_perm_b32 v137, v148, v144, s23
    v_perm_b32 v138, v149, v145, s22
    v_perm_b32 v139, v149, v145, s23
    v_perm_b32 v140, v150, v146, s22
    v_perm_b32 v141, v150, v146, s23
    v_perm_b32 v142, v151, v147, s22
    v_perm_b32 v143, v151, v147, s23
    v_perm_b32 v144, v156, v152, s22
    v_perm_b32 v145, v156, v152, s23
    v_perm_b32 v146, v157, v153, s22
    v_perm_b32 v147, v157, v153, s23
    v_perm_b32 v148, v158, v154, s22
    v_perm_b32 v149, v158, v154, s23
    v_perm_b32 v150, v159, v155, s22
    v_perm_b32 v151, v159, v155, s23
    v_perm_b32 v152, v164, v160, s22
    v_perm_b32 v153, v164, v160, s23
    v_perm_b32 v154, v165, v161, s22
    v_perm_b32 v155, v165, v161, s23
    v_perm_b32 v156, v166, v162, s22
    v_perm_b32 v157, v166, v162, s23
    v_perm_b32 v158, v167, v163, s22
    v_perm_b32 v159, v167, v163, s23
    v_perm_b32 v160, v172, v168, s22
    v_perm_b32 v161, v172, v168, s23
    v_perm_b32 v162, v173, v169, s22
    v_perm_b32 v163, v173, v169, s23
    v_perm_b32 v164, v174, v170, s22
    v_perm_b32 v165, v174, v170, s23
    v_perm_b32 v166, v175, v171, s22
    v_perm_b32 v167, v175, v171, s23
    v_perm_b32 v168, v180, v176, s22
    v_perm_b32 v169, v180, v176, s23
    v_perm_b32 v170, v181, v177, s22
    v_perm_b32 v171, v181, v177, s23
    v_perm_b32 v172, v182, v178, s22
    v_perm_b32 v173, v182, v178, s23
    v_perm_b32 v174, v183, v179, s22
    v_perm_b32 v175, v183, v179, s23
    v_perm_b32 v176, v188, v184, s22
    v_perm_b32 v177, v188, v184, s23
    v_perm_b32 v178, v189, v185, s22
    v_perm_b32 v179, v189, v185, s23
    v_perm_b32 v180, v190, v186, s22
    v_perm_b32 v181, v190, v186, s23
    v_perm_b32 v182, v191, v187, s22
    v_perm_b32 v183, v191, v187, s23
    v_perm_b32 v184, v196, v192, s22
    v_perm_b32 v185, v196, v192, s23
    v_perm_b32 v186, v197, v193, s22
    v_perm_b32 v187, v197, v193, s23
    v_perm_b32 v188, v198, v194, s22
    v_perm_b32 v189, v198, v194, s23
    v_perm_b32 v190, v199, v195, s22
    v_perm_b32 v191, v199, v195, s23
    s_cmp_lt_u32 s3, 6
    s_cbranch_scc1 L_HW
    s_and_b32 s15, s3, 1
    s_lshl_b32 s14, s15, 11
    s_and_b32 s16, s76, 3
    s_lshl_b32 s16, s16, 13
    s_add_u32 s14, s14, s16
    s_add_u32 s14, s14, 196608
    s_sleep 30
    v_lshlrev_b32 v6, 4, v0
    v_add_u32 v6, s14, v6
    v_add_u32 v72, 0x1000, v6
    s_mov_b32 s21, 200000
    global_load_dwordx4 v[56:59], v6, s[8:9] sc1
    global_load_dwordx4 v[60:63], v6, s[8:9] offset:1024 sc1
    global_load_dwordx4 v[64:67], v72, s[8:9] sc1
    global_load_dwordx4 v[68:71], v72, s[8:9] offset:1024 sc1
KPH_5:
    s_waitcnt vmcnt(0)
    v_xor_b32 v2, s20, v57
    v_bitop3_b32 v2, v2, v59, s20 bitop3:0xf6
    v_cmp_ne_u32 s[60:61], 0, v2
    v_xor_b32 v3, s20, v61
    v_bitop3_b32 v3, v3, v63, s20 bitop3:0xf6
    v_cmp_ne_u32 s[62:63], 0, v3
    v_xor_b32 v2, s20, v65
    v_bitop3_b32 v2, v2, v67, s20 bitop3:0xf6
    v_cmp_ne_u32 s[64:65], 0, v2
    v_xor_b32 v3, s20, v69
    v_bitop3_b32 v3, v3, v71, s20 bitop3:0xf6
    v_cmp_ne_u32 s[66:67], 0, v3
    s_or_b64 s[78:79], s[60:61], s[62:63]
    s_or_b64 s[78:79], s[78:79], s[64:65]
    s_or_b64 s[78:79], s[78:79], s[66:67]
    s_cbranch_scc0 KEH_6
    s_sleep 2
    s_mov_b64 exec, s[60:61]
    global_load_dwordx4 v[56:59], v6, s[8:9] sc1
    s_mov_b64 exec, s[62:63]
    global_load_dwordx4 v[60:63], v6, s[8:9] offset:1024 sc1
    s_mov_b64 exec, s[64:65]
    global_load_dwordx4 v[64:67], v72, s[8:9] sc1
    s_mov_b64 exec, s[66:67]
    global_load_dwordx4 v[68:71], v72, s[8:9] offset:1024 sc1
    s_mov_b64 exec, -1
    s_sub_u32 s21, s21, 1
    s_cbranch_scc0 KPH_5
    s_waitcnt vmcnt(0)
KEH_6:
    v_lshlrev_b32 v80, 16, v56
    v_and_b32 v81, 0xffff0000, v56
    v_lshlrev_b32 v82, 16, v58
    v_and_b32 v83, 0xffff0000, v58
    v_lshlrev_b32 v84, 16, v60
    v_and_b32 v85, 0xffff0000, v60
    v_lshlrev_b32 v86, 16, v62
    v_and_b32 v87, 0xffff0000, v62
    v_lshlrev_b32 v88, 16, v64
    v_and_b32 v89, 0xffff0000, v64
    v_lshlrev_b32 v90, 16, v66
    v_and_b32 v91, 0xffff0000, v66
    v_lshlrev_b32 v92, 16, v68
    v_and_b32 v93, 0xffff0000, v68
    v_lshlrev_b32 v94, 16, v70
    v_and_b32 v95, 0xffff0000, v70
    v_add_f32 v88, 1.0, v88
    v_add_f32 v89, 1.0, v89
    v_add_f32 v90, 1.0, v90
    v_add_f32 v91, 1.0, v91
    v_add_f32 v92, 1.0, v92
    v_add_f32 v93, 1.0, v93
    v_add_f32 v94, 1.0, v94
    v_add_f32 v95, 1.0, v95
    v_cvt_pk_bf16_f32 v56, v88, v89
    v_lshlrev_b32 v88, 16, v56
    v_and_b32 v89, 0xffff0000, v56
    v_cvt_pk_bf16_f32 v57, v90, v91
    v_lshlrev_b32 v90, 16, v57
    v_and_b32 v91, 0xffff0000, v57
    v_cvt_pk_bf16_f32 v58, v92, v93
    v_lshlrev_b32 v92, 16, v58
    v_and_b32 v93, 0xffff0000, v58
    v_cvt_pk_bf16_f32 v59, v94, v95
    v_lshlrev_b32 v94, 16, v59
    v_and_b32 v95, 0xffff0000, v59
    v_pk_mul_f32 v[32:33], v[32:33], v[88:89]
    v_pk_mul_f32 v[34:35], v[34:35], v[90:91]
    v_pk_mul_f32 v[36:37], v[36:37], v[92:93]
    v_pk_mul_f32 v[38:39], v[38:39], v[94:95]
    v_cvt_pk_bf16_f32 v56, v32, v33
    v_lshlrev_b32 v32, 16, v56
    v_and_b32 v33, 0xffff0000, v56
    v_cvt_pk_bf16_f32 v57, v34, v35
    v_lshlrev_b32 v34, 16, v57
    v_and_b32 v35, 0xffff0000, v57
    v_cvt_pk_bf16_f32 v58, v36, v37
    v_lshlrev_b32 v36, 16, v58
    v_and_b32 v37, 0xffff0000, v58
    v_cvt_pk_bf16_f32 v59, v38, v39
    v_lshlrev_b32 v38, 16, v59
    v_and_b32 v39, 0xffff0000, v59
    v_pk_add_f32 v[32:33], v[32:33], v[80:81]
    v_pk_add_f32 v[34:35], v[34:35], v[82:83]
    v_pk_add_f32 v[36:37], v[36:37], v[84:85]
    v_pk_add_f32 v[38:39], v[38:39], v[86:87]
    v_cvt_pk_bf16_f32 v60, v32, v33
    v_cvt_pk_bf16_f32 v61, v34, v35
    v_cvt_pk_bf16_f32 v62, v36, v37
    v_cvt_pk_bf16_f32 v63, v38, v39
    s_lshl_b32 s14, s15, 10
    v_add_u32 v6, s14, v30
    ds_write_b64 v6, v[60:61] offset:1312
    ds_write_b64 v6, v[62:63] offset:1824
    s_waitcnt lgkmcnt(0)
    s_lshl_b32 s14, s15, 2
    v_mov_b32 v2, s14
    v_mov_b32 v3, 1
    ds_write_b32 v2, v3 offset:1056
L_HW:
    s_mov_b32 s21, 1600000
    v_mov_b32 v68, 0
FWH_7:
    ds_read_b64 v[64:65], v68 offset:1056
    s_waitcnt lgkmcnt(0)
    v_and_b32 v64, v64, v65
    v_cmp_ne_u32 vcc, 1, v64
    s_nop 0
    s_cbranch_vccz FDH_8
    s_sub_u32 s21, s21, 1
    s_cbranch_scc0 FWH_7
FDH_8:
    ds_read_b128 v[24:27], v18 offset:1312
    ds_read_b128 v[28:31], v18 offset:1328
    ds_read_b128 v[32:35], v18 offset:2336
    ds_read_b128 v[36:39], v18 offset:2352
    s_and_b32 s15, s76, 63
    s_lshl_b32 s15, s15, 8
    s_add_u32 s15, s15, 65536
    s_waitcnt lgkmcnt(0)
    v_dot2_f32_bf16 v56, v128, v24, 0
    v_dot2_f32_bf16 v57, v129, v24, 0
    v_dot2_f32_bf16 v58, v130, v24, 0
    v_dot2_f32_bf16 v59, v131, v24, 0
    v_dot2_f32_bf16 v60, v132, v24, 0
    v_dot2_f32_bf16 v61, v133, v24, 0
    v_dot2_f32_bf16 v62, v134, v24, 0
    v_dot2_f32_bf16 v63, v135, v24, 0
    v_dot2_f32_bf16 v64, v128, v32, 0
    v_dot2_f32_bf16 v65, v129, v32, 0
    v_dot2_f32_bf16 v66, v130, v32, 0
    v_dot2_f32_bf16 v67, v131, v32, 0
    v_dot2_f32_bf16 v68, v132, v32, 0
    v_dot2_f32_bf16 v69, v133, v32, 0
    v_dot2_f32_bf16 v70, v134, v32, 0
    v_dot2_f32_bf16 v71, v135, v32, 0
    v_dot2_f32_bf16 v56, v136, v25, v56
    v_dot2_f32_bf16 v57, v137, v25, v57
    v_dot2_f32_bf16 v58, v138, v25, v58
    v_dot2_f32_bf16 v59, v139, v25, v59
    v_dot2_f32_bf16 v60, v140, v25, v60
    v_dot2_f32_bf16 v61, v141, v25, v61
    v_dot2_f32_bf16 v62, v142, v25, v62
    v_dot2_f32_bf16 v63, v143, v25, v63
    v_dot2_f32_bf16 v64, v136, v33, v64
    v_dot2_f32_bf16 v65, v137, v33, v65
    v_dot2_f32_bf16 v66, v138, v33, v66
    v_dot2_f32_bf16 v67, v139, v33, v67
    v_dot2_f32_bf16 v68, v140, v33, v68
    v_dot2_f32_bf16 v69, v141, v33, v69
    v_dot2_f32_bf16 v70, v142, v33, v70
    v_dot2_f32_bf16 v71, v143, v33, v71
    v_dot2_f32_bf16 v56, v144, v26, v56
    v_dot2_f32_bf16 v57, v145, v26, v57
    v_dot2_f32_bf16 v58, v146, v26, v58
    v_dot2_f32_bf16 v59, v147, v26, v59
    v_dot2_f32_bf16 v60, v148, v26, v60
    v_dot2_f32_bf16 v61, v149, v26, v61
    v_dot2_f32_bf16 v62, v150, v26, v62
    v_dot2_f32_bf16 v63, v151, v26, v63
    v_dot2_f32_bf16 v64, v144, v34, v64
    v_dot2_f32_bf16 v65, v145, v34, v65
    v_dot2_f32_bf16 v66, v146, v34, v66
    v_dot2_f32_bf16 v67, v147, v34, v67
    v_dot2_f32_bf16 v68, v148, v34, v68
    v_dot2_f32_bf16 v69, v149, v34, v69
    v_dot2_f32_bf16 v70, v150, v34, v70
    v_dot2_f32_bf16 v71, v151, v34, v71
    v_dot2_f32_bf16 v56, v152, v27, v56
    v_dot2_f32_bf16 v57, v153, v27, v57
    v_dot2_f32_bf16 v58, v154, v27, v58
    v_dot2_f32_bf16 v59, v155, v27, v59
    v_dot2_f32_bf16 v60, v156, v27, v60
    v_dot2_f32_bf16 v61, v157, v27, v61
    v_dot2_f32_bf16 v62, v158, v27, v62
    v_dot2_f32_bf16 v63, v159, v27, v63
    v_dot2_f32_bf16 v64, v152, v35, v64
    v_dot2_f32_bf16 v65, v153, v35, v65
    v_dot2_f32_bf16 v66, v154, v35, v66
    v_dot2_f32_bf16 v67, v155, v35, v67
    v_dot2_f32_bf16 v68, v156, v35, v68
    v_dot2_f32_bf16 v69, v157, v35, v69
    v_dot2_f32_bf16 v70, v158, v35, v70
    v_dot2_f32_bf16 v71, v159, v35, v71
    v_dot2_f32_bf16 v56, v160, v28, v56
    v_dot2_f32_bf16 v57, v161, v28, v57
    v_dot2_f32_bf16 v58, v162, v28, v58
    v_dot2_f32_bf16 v59, v163, v28, v59
    v_dot2_f32_bf16 v60, v164, v28, v60
    v_dot2_f32_bf16 v61, v165, v28, v61
    v_dot2_f32_bf16 v62, v166, v28, v62
    v_dot2_f32_bf16 v63, v167, v28, v63
    v_dot2_f32_bf16 v64, v160, v36, v64
    v_dot2_f32_bf16 v65, v161, v36, v65
    v_dot2_f32_bf16 v66, v162, v36, v66
    v_dot2_f32_bf16 v67, v163, v36, v67
    v_dot2_f32_bf16 v68, v164, v36, v68
    v_dot2_f32_bf16 v69, v165, v36, v69
    v_dot2_f32_bf16 v70, v166, v36, v70
    v_dot2_f32_bf16 v71, v167, v36, v71
    v_dot2_f32_bf16 v56, v168, v29, v56
    v_dot2_f32_bf16 v57, v169, v29, v57
    v_dot2_f32_bf16 v58, v170, v29, v58
    v_dot2_f32_bf16 v59, v171, v29, v59
    v_dot2_f32_bf16 v60, v172, v29, v60
    v_dot2_f32_bf16 v61, v173, v29, v61
    v_dot2_f32_bf16 v62, v174, v29, v62
    v_dot2_f32_bf16 v63, v175, v29, v63
    v_dot2_f32_bf16 v64, v168, v37, v64
    v_dot2_f32_bf16 v65, v169, v37, v65
    v_dot2_f32_bf16 v66, v170, v37, v66
    v_dot2_f32_bf16 v67, v171, v37, v67
    v_dot2_f32_bf16 v68, v172, v37, v68
    v_dot2_f32_bf16 v69, v173, v37, v69
    v_dot2_f32_bf16 v70, v174, v37, v70
    v_dot2_f32_bf16 v71, v175, v37, v71
    v_dot2_f32_bf16 v56, v176, v30, v56
    v_dot2_f32_bf16 v57, v177, v30, v57
    v_dot2_f32_bf16 v58, v178, v30, v58
    v_dot2_f32_bf16 v59, v179, v30, v59
    v_dot2_f32_bf16 v60, v180, v30, v60
    v_dot2_f32_bf16 v61, v181, v30, v61
    v_dot2_f32_bf16 v62, v182, v30, v62
    v_dot2_f32_bf16 v63, v183, v30, v63
    v_dot2_f32_bf16 v64, v176, v38, v64
    v_dot2_f32_bf16 v65, v177, v38, v65
    v_dot2_f32_bf16 v66, v178, v38, v66
    v_dot2_f32_bf16 v67, v179, v38, v67
    v_dot2_f32_bf16 v68, v180, v38, v68
    v_dot2_f32_bf16 v69, v181, v38, v69
    v_dot2_f32_bf16 v70, v182, v38, v70
    v_dot2_f32_bf16 v71, v183, v38, v71
    v_dot2_f32_bf16 v56, v184, v31, v56
    v_dot2_f32_bf16 v57, v185, v31, v57
    v_dot2_f32_bf16 v58, v186, v31, v58
    v_dot2_f32_bf16 v59, v187, v31, v59
    v_dot2_f32_bf16 v60, v188, v31, v60
    v_dot2_f32_bf16 v61, v189, v31, v61
    v_dot2_f32_bf16 v62, v190, v31, v62
    v_dot2_f32_bf16 v63, v191, v31, v63
    v_dot2_f32_bf16 v64, v184, v39, v64
    v_dot2_f32_bf16 v65, v185, v39, v65
    v_dot2_f32_bf16 v66, v186, v39, v66
    v_dot2_f32_bf16 v67, v187, v39, v67
    v_dot2_f32_bf16 v68, v188, v39, v68
    v_dot2_f32_bf16 v69, v189, v39, v69
    v_dot2_f32_bf16 v70, v190, v39, v70
    v_dot2_f32_bf16 v71, v191, v39, v71
    v_permlane32_swap_b32 v56, v64
    v_permlane32_swap_b32 v57, v65
    v_permlane32_swap_b32 v58, v66
    v_permlane32_swap_b32 v59, v67
    v_permlane32_swap_b32 v60, v68
    v_permlane32_swap_b32 v61, v69
    v_permlane32_swap_b32 v62, v70
    v_permlane32_swap_b32 v63, v71
    v_add_f32 v56, v56, v64
    v_add_f32 v57, v57, v65
    v_add_f32 v58, v58, v66
    v_add_f32 v59, v59, v67
    v_add_f32 v60, v60, v68
    v_add_f32 v61, v61, v69
    v_add_f32 v62, v62, v70
    v_add_f32 v63, v63, v71
    v_permlane16_swap_b32 v56, v60
    v_permlane16_swap_b32 v57, v61
    v_permlane16_swap_b32 v58, v62
    v_permlane16_swap_b32 v59, v63
    v_add_f32 v56, v56, v60
    v_add_f32 v57, v57, v61
    v_add_f32 v58, v58, v62
    v_add_f32 v59, v59, v63
    v_add_f32_dpp v56, v56, v56 row_ror:8 row_mask:0xf bank_mask:0x3
    v_add_f32_dpp v57, v57, v57 row_ror:8 row_mask:0xf bank_mask:0x3
    s_nop 0
    v_add_f32_dpp v56, v58, v58 row_ror:8 row_mask:0xf bank_mask:0xc
    v_add_f32_dpp v57, v59, v59 row_ror:8 row_mask:0xf bank_mask:0xc
    ds_write_b64 v23, v[56:57] offset:11776
    s_waitcnt lgkmcnt(0)
    s_lshl_b32 s14, s18, 2
    v_mov_b32 v2, s14
    v_mov_b32 v3, 1
    ds_write_b32 v2, v3 offset:1040
    s_cmp_lg_u32 s18, 0
    s_cbranch_scc1 L_QEND
    v_lshlrev_b32 v72, 14, v21
    v_add_u32 v72, v72, v20
    v_add_u32 v72, s15, v72
    s_mov_b32 s21, 1600000
    v_mov_b32 v68, 0
FWQ_9:
    ds_read_b128 v[64:67], v68 offset:1040
    s_waitcnt lgkmcnt(0)
    v_and_b32 v64, v64, v65
    v_bitop3_b32 v64, v64, v66, v67 bitop3:0x80
    v_cmp_ne_u32 vcc, 1, v64
    s_nop 0
    s_cbranch_vccz FDQ_10
    s_sub_u32 s21, s21, 1
    s_cbranch_scc0 FWQ_9
FDQ_10:
    ds_read_b64 v[56:57], v22 offset:11776
    ds_read_b64 v[58:59], v22 offset:12288
    ds_read_b64 v[60:61], v22 offset:12800
    ds_read_b64 v[62:63], v22 offset:13312
    s_waitcnt lgkmcnt(0)
    v_pk_add_f32 v[56:57], v[56:57], v[58:59]
    v_pk_add_f32 v[60:61], v[60:61], v[62:63]
    v_pk_add_f32 v[56:57], v[56:57], v[60:61]
    v_cvt_pk_bf16_f32 v56, v56, v57
    v_mov_b32 v57, s20
    global_store_dwordx2 v72, v[56:57], s[8:9] sc1
L_QEND:
L_HELP2:
    s_cmp_lg_u32 s3, 6
    s_cbranch_scc1 L_HBAR1
    s_cmp_ge_u32 s77, 48
    s_cbranch_scc1 L_NOQS
    s_sleep 80
L_NOQS:
    s_lshr_b32 s14, s76, 6
    s_cmp_eq_u32 s14, 1
    s_cbranch_scc1 L_QQ
    s_sleep 100
    s_branch L_QQ2
L_QQ:
    s_sleep 40
L_QQ2:
    s_lshl_b32 s14, s10, 11
    s_add_u32 s14, s14, 65536
    v_lshlrev_b32 v6, 4, v0
    v_add_u32 v6, s14, v6
    s_mov_b32 s21, 200000
    global_load_dwordx4 v[40:43], v6, s[8:9] sc1
    global_load_dwordx4 v[44:47], v6, s[8:9] offset:1024 sc1
KPQ_11:
    s_waitcnt vmcnt(0)
    v_xor_b32 v2, s20, v41
    v_bitop3_b32 v2, v2, v43, s20 bitop3:0xf6
    v_cmp_ne_u32 s[60:61], 0, v2
    v_xor_b32 v3, s20, v45
    v_bitop3_b32 v3, v3, v47, s20 bitop3:0xf6
    v_cmp_ne_u32 s[62:63], 0, v3
    s_nop 0
    s_or_b64 s[78:79], s[60:61], s[62:63]
    s_cbranch_scc0 KEQ_12
    s_sleep 4
    s_mov_b64 exec, s[60:61]
    global_load_dwordx4 v[40:43], v6, s[8:9] sc1
    s_mov_b64 exec, s[62:63]
    global_load_dwordx4 v[44:47], v6, s[8:9] offset:1024 sc1
    s_mov_b64 exec, -1
    s_sub_u32 s21, s21, 1
    s_cbranch_scc0 KPQ_11
    s_waitcnt vmcnt(0)
KEQ_12:
    v_mov_b32 v41, v42
    v_mov_b32 v42, v44
    v_mov_b32 v43, v46
    v_lshlrev_b32 v6, 3, v0
    ds_write_b64 v6, v[40:41] offset:0
    ds_write_b64 v6, v[42:43] offset:512
    v_mov_b32 v9, s20
    ds_write_b32 v4, v9 offset:1024
    s_waitcnt lgkmcnt(0)
    v_mov_b32 v2, 0
    v_mov_b32 v3, 1
    ds_write_b32 v2, v3 offset:1088
    s_waitcnt lgkmcnt(0)
L_HBAR1:
    s_sub_u32 s14, s76, 128
    s_cmp_ge_u32 s14, 64
    s_cbranch_scc1 L_RPRE0
    s_bfe_u32 s14, s76, 0x20004
    s_lshl_b32 s13, s14, 4
    s_and_b32 s14, s76, 7
    s_lshl_b32 s14, s14, 1
    s_add_u32 s13, s13, s14
    s_bfe_u32 s14, s76, 0x10003
    s_add_u32 s13, s13, s14
    s_lshr_b32 s14, s76, 6
    s_cmp_eq_u32 s14, 2
    s_cselect_b32 s13, s13, 99
    s_cmp_ge_u32 s13, 56
    s_cbranch_scc1 L_WOW
    s_and_b32 s15, s3, 1
    s_lshl_b32 s14, s15, 11
    s_add_u32 s14, s14, 53248
    s_and_b32 s15, s3, 2
    s_lshl_b32 s15, s15, 9
    s_add_u32 s14, s14, s15
    s_mov_b32 s21, 1600000
    v_mov_b32 v68, 0
FWSQ_13:
    ds_read_b32 v64, v68 offset:1088
    s_waitcnt lgkmcnt(0)
    v_cmp_ne_u32 vcc, 1, v64
    s_nop 0
    s_cbranch_vccz FDSQ_14
    s_sleep 8
    s_sub_u32 s21, s21, 1
    s_cbranch_scc0 FWSQ_13
FDSQ_14:
    v_add_u32 v6, s14, v5
    v_add_u32 v56, 0x1000, v6
    s_mov_b32 s21, 200000
POLLSB_15:
    global_load_dwordx4 v[40:43], v6, s[8:9] sc1
    global_load_dwordx4 v[48:51], v56, s[8:9] sc1
    s_waitcnt vmcnt(0)
    v_xor_b32 v2, s20, v41
    v_bitop3_b32 v2, v2, v43, s20 bitop3:0xf6
    v_bitop3_b32 v2, v2, v49, s20 bitop3:0xf6
    v_bitop3_b32 v2, v2, v51, s20 bitop3:0xf6
    v_cmp_ne_u32 vcc, 0, v2
    s_nop 0
    s_cbranch_vccz PDSB_16
    s_sleep 8
    s_sub_u32 s21, s21, 1
    s_cbranch_scc0 POLLSB_15
PDSB_16:
    v_lshlrev_b32 v208, 16, v40
    v_and_b32 v209, 0xffff0000, v40
    v_lshlrev_b32 v210, 16, v42
    v_and_b32 v211, 0xffff0000, v42
    v_lshlrev_b32 v212, 16, v44
    v_and_b32 v213, 0xffff0000, v44
    v_lshlrev_b32 v214, 16, v46
    v_and_b32 v215, 0xffff0000, v46
    v_lshlrev_b32 v216, 16, v48
    v_and_b32 v217, 0xffff0000, v48
    v_lshlrev_b32 v218, 16, v50
    v_and_b32 v219, 0xffff0000, v50
    v_lshlrev_b32 v220, 16, v52
    v_and_b32 v221, 0xffff0000, v52
    v_lshlrev_b32 v222, 16, v54
    v_and_b32 v223, 0xffff0000, v54
    v_add_f32 v216, 1.0, v216
    v_add_f32 v217, 1.0, v217
    v_add_f32 v218, 1.0, v218
    v_add_f32 v219, 1.0, v219
    v_add_f32 v220, 1.0, v220
    v_add_f32 v221, 1.0, v221
    v_add_f32 v222, 1.0, v222
    v_add_f32 v223, 1.0, v223
    v_cvt_pk_bf16_f32 v40, v216, v217
    v_lshlrev_b32 v216, 16, v40
    v_and_b32 v217, 0xffff0000, v40
    v_cvt_pk_bf16_f32 v41, v218, v219
    v_lshlrev_b32 v218, 16, v41
    v_and_b32 v219, 0xffff0000, v41
    v_cvt_pk_bf16_f32 v42, v220, v221
    v_lshlrev_b32 v220, 16, v42
    v_and_b32 v221, 0xffff0000, v42
    v_cvt_pk_bf16_f32 v43, v222, v223
    v_lshlrev_b32 v222, 16, v43
    v_and_b32 v223, 0xffff0000, v43
    s_branch L_WOW
L_RPRE0:
    s_cmp_lg_u32 s3, 5
    s_cbranch_scc1 L_WOW
    s_sub_u32 s13, s76, 192
    s_cmp_ge_u32 s13, 32
    s_cbranch_scc1 L_WOW
    s_and_b32 s14, s13, 3
    s_lshl_b32 s14, s14, 1
    s_bfe_u32 s15, s13, 0x10002
    s_and_b32 s13, s13, 24
    s_or_b32 s13, s13, s14
    s_or_b32 s13, s13, s15
    s_lshl_b32 s15, s13, 6
    s_add_u32 s15, s15, 49152
    v_and_b32 v12, 3, v0
    v_bfe_u32 v8, v0, 4, 1
    v_lshl_add_u32 v12, v12, 1, v8
    v_bfe_u32 v8, v0, 2, 1
    v_lshlrev_b32 v6, 3, v12
    v_lshl_add_u32 v6, v8, 11, v6
    v_add_u32 v6, s15, v6
    v_add_u32 v13, 12288, v6
    s_mov_b32 s21, 1600000
    v_mov_b32 v68, 0
FWRQ_17:
    ds_read_b32 v64, v68 offset:1088
    s_waitcnt lgkmcnt(0)
    v_cmp_ne_u32 vcc, 1, v64
    s_nop 0
    s_cbranch_vccz FDRQ_18
    s_sleep 8
    s_sub_u32 s21, s21, 1
    s_cbranch_scc0 FWRQ_17
FDRQ_18:
    s_sleep 60
    v_lshlrev_b32 v14, 8, v0
    v_add_u32 v14, 65536, v14
    s_mov_b32 s21, 200000
POLLGA_19:
    global_load_dwordx2 v[40:41], v6, s[8:9] sc1
    global_load_dwordx2 v[42:43], v13, s[8:9] sc1
    global_load_dwordx2 v[44:45], v14, s[8:9] sc1
    s_waitcnt vmcnt(0)
    v_xor_b32 v2, s20, v41
    v_bitop3_b32 v2, v2, v43, s20 bitop3:0xf6
    v_bitop3_b32 v2, v2, v45, s20 bitop3:0xf6
    v_cmp_ne_u32 vcc, 0, v2
    s_nop 0
    s_cbranch_vccz PDGA_20
    s_sleep 16
    s_sub_u32 s21, s21, 1
    s_cbranch_scc0 POLLGA_19
PDGA_20:
    v_lshrrev_b32 v9, 1, v0
    v_and_b32 v9, 16, v9
    v_sub_u32 v9, 16, v9
    v_lshlrev_b32 v208, v9, v40
    v_and_b32 v208, 0xffff0000, v208
    v_lshlrev_b32 v209, v9, v42
    v_and_b32 v209, 0xffff0000, v209
    v_bfe_u32 v9, v0, 5, 1
    v_lshl_add_u32 v6, v12, 1, v9
    v_lshl_add_u32 v6, v8, 9, v6
    s_lshl_b32 s15, s13, 4
    v_add_u32 v6, s15, v6
    v_lshlrev_b32 v204, 1, v6
    global_load_ushort v210, v204, s[40:41]
    s_and_b32 s14, s13, 28
    s_lshl_b32 s14, s14, 12
    s_and_b32 s15, s13, 1
    s_lshl_b32 s15, s15, 13
    s_add_u32 s14, s14, s15
    s_and_b32 s15, s13, 2
    s_lshl_b32 s15, s15, 11
    s_add_u32 s14, s14, s15
    s_add_u32 s14, s14, 1572864
    v_add_u32 v200, s14, v5
    s_mul_i32 s14, s13, 128
    s_add_u32 s14, s14, 131072
    v_bfe_u32 v9, v0, 3, 2
    v_mul_u32_u24 v201, 4096, v9
    v_mul_u32_u24 v10, 64, v8
    v_lshl_add_u32 v201, v12, 3, v201
    v_add3_u32 v201, v201, v10, s14
    v_add_u32 v205, 16384, v201
    v_and_b32 v9, 8, v0
    v_lshlrev_b32 v201, 9, v9
    v_and_b32 v9, 32, v0
    v_lshl_add_u32 v201, v9, 9, v201
    v_lshl_add_u32 v201, v12, 3, v201
    v_add3_u32 v201, v201, v10, s14
    v_add_u32 v205, 0x2000, v201
    s_mul_i32 s14, s13, 8192
    s_add_u32 s14, s14, 1835008
    v_add_u32 v202, s14, v5
    v_add_u32 v203, 0x1000, v202
    v_and_b32 v12, 8, v0
    v_cmp_eq_u32 s[42:43], 0, v12
    v_mov_b32 v213, s20
    v_mov_b32 v44, -1
    v_mov_b32 v45, -1
    v_mov_b32 v46, -1
    v_mov_b32 v47, -1
    v_mov_b32 v207, s20
    s_waitcnt vmcnt(0)
    v_lshlrev_b32 v210, 16, v210
L_WOW:
    s_bfe_u32 s26, s2, 0x50002
    s_and_b32 s27, s11, 3
    s_lshl_b32 s27, s27, 1
    s_add_u32 s27, s27, s12
    v_and_b32 v14, 15, v0
    v_lshrrev_b32 v15, 4, v0
    v_and_b32 v8, 1, v0
    v_bfe_u32 v13, v0, 1, 3
    s_lshl_b32 s14, s26, 2
    s_add_u32 s14, s14, s18
    s_lshl_b32 s14, s14, 11
    s_add_u32 s14, s14, 1048576
    v_lshlrev_b32 v9, 18, v8
    v_bfe_u32 v10, v0, 2, 2
    v_lshl_add_u32 v9, v10, 7, v9
    v_lshl_add_u32 v9, v15, 5, v9
    v_bfe_u32 v10, v0, 1, 1
    v_lshl_add_u32 v9, v10, 4, v9
    v_add_u32 v9, s14, v9
    s_mov_b32 s30, 0x0c04000c
    s_lshl_b32 s14, s26, 11
    s_add_u32 s14, s14, 262144
    v_lshlrev_b32 v10, 16, v8
    v_lshl_add_u32 v10, v13, 8, v10
    v_add_u32 v10, s14, v10
    s_lshl_b32 s14, s27, 7
    s_add_u32 s14, s14, s26
    s_lshl_b32 s14, s14, 7
    s_add_u32 s14, s14, 1572864
    v_and_b32 v12, 8, v0
    v_lshlrev_b32 v11, 10, v12
    v_and_b32 v12, 16, v0
    v_lshl_add_u32 v11, v12, 8, v11
    v_and_b32 v12, 0x70, v5
    v_add3_u32 v11, v11, v12, s14
    s_lshl_b32 s14, s18, 9
    v_lshlrev_b32 v12, 4, v14
    v_lshl_add_u32 v12, v15, 2, v12
    s_add_u32 s14, s14, 11776
    v_add_u32 v12, s14, v12
    v_bfe_u32 v13, v0, 3, 2
    v_lshlrev_b32 v13, 6, v13
    v_and_b32 v16, 4, v0
    v_lshl_add_u32 v13, v16, 6, v13
    v_and_b32 v16, 48, v5
    v_add_u32 v13, v13, v16
    s_lshl_b32 s14, s26, 7
    s_lshl_b32 s15, s18, 1
    s_add_u32 s14, s14, s15
    s_lshl_b32 s14, s14, 10
    s_lshl_b32 s15, s27, 7
    s_add_u32 s14, s14, s15
    s_add_u32 s24, s46, s14
    s_addc_u32 s25, s47, 0
    v_bfe_u32 v6, v0, 4, 1
    v_lshlrev_b32 v6, 16, v6
    v_lshrrev_b32 v16, 5, v0
    v_lshl_add_u32 v6, v16, 10, v6
    v_lshl_add_u32 v6, v14, 3, v6
    v_cmp_eq_u32 s[84:85], 1, v15
    v_cmp_eq_u32 s[86:87], 2, v15
    v_cmp_eq_u32 s[88:89], 3, v15
    s_setprio 0
    s_cmp_lg_u32 s3, 4
    s_cbranch_scc1 L_DSKIP
    s_mov_b64 exec, 0
    s_branch L_DW2
L_DDONE:
    s_mov_b64 exec, -1
    s_mov_b32 s30, 0x0c04000c
L_DSKIP:
    s_cmp_lg_u32 s3, 6
    s_cbranch_scc1 L_NPD
    s_nop 2
    v_mov_b32 v64, 36864
    s_mov_b32 s21, 200000
POLLNP_21:
    global_load_dwordx2 v[66:67], v64, s[8:9] sc1
    s_waitcnt vmcnt(0)
    v_xor_b32 v2, s20, v67
    v_cmp_ne_u32 vcc, 0, v2
    s_nop 0
    s_cbranch_vccz PDNP_22
    s_sleep 100
    s_sub_u32 s21, s21, 1
    s_cbranch_scc0 POLLNP_21
PDNP_22:
    v_and_b32 v66, 8192, v66
    ds_write_b32 v4, v66 offset:1152
    s_waitcnt lgkmcnt(0)
L_NPD:
    s_mov_b32 s21, 1600000
L_XW:
    s_nop 1
    ds_read_b32 v64, v4 offset:1096
    s_waitcnt lgkmcnt(0)
    v_cmp_gt_u32 vcc, 2, v64
    s_nop 0
    s_cbranch_vccz L_XD
    s_sleep 1
    s_sub_u32 s21, s21, 1
    s_cbranch_scc0 L_XW
L_XD:
    s_setprio 3
    global_load_dwordx2 v[96:97], v6, s[24:25] nt
    s_add_u32 s24, s24, 8192
    s_addc_u32 s25, s25, 0
    global_load_dwordx2 v[98:99], v6, s[24:25] nt
    s_add_u32 s24, s24, 8192
    s_addc_u32 s25, s25, 0
    global_load_dwordx2 v[100:101], v6, s[24:25] nt
    s_add_u32 s24, s24, 8192
    s_addc_u32 s25, s25, 0
    global_load_dwordx2 v[102:103], v6, s[24:25] nt
    s_add_u32 s24, s24, 8192
    s_addc_u32 s25, s25, 0
    global_load_dwordx2 v[104:105], v6, s[24:25] nt
    s_add_u32 s24, s24, 8192
    s_addc_u32 s25, s25, 0
    global_load_dwordx2 v[106:107], v6, s[24:25] nt
    s_add_u32 s24, s24, 8192
    s_addc_u32 s25, s25, 0
    global_load_dwordx2 v[108:109], v6, s[24:25] nt
    s_add_u32 s24, s24, 8192
    s_addc_u32 s25, s25, 0
    global_load_dwordx2 v[110:111], v6, s[24:25] nt
    s_barrier
L_DW2:
    ds_read_b32 v70, v4 offset:1152
    s_waitcnt lgkmcnt(0)
    v_xor_b32 v9, v9, v70
    v_xor_b32 v11, v11, v70
    v_xor_b32 v200, v200, v70
    v_xor_b32 v201, v201, v70
    v_xor_b32 v202, v202, v70
    v_xor_b32 v203, v203, v70
    v_xor_b32 v205, v205, v70
    v_readfirstlane_b32 s92, v70
    s_mov_b32 s21, 1600000
    v_mov_b32 v68, 0
FWS3_23:
    ds_read_b128 v[64:67], v68 offset:1136
    s_waitcnt lgkmcnt(0)
    v_and_b32 v64, v64, v65
    v_bitop3_b32 v64, v64, v66, v67 bitop3:0x80
    v_cmp_ne_u32 vcc, 1, v64
    s_nop 0
    s_cbranch_vccz FDS3_24
    s_sub_u32 s21, s21, 1
    s_cbranch_scc0 FWS3_23
FDS3_24:
    s_cbranch_execz L_DW3
    global_load_dwordx4 v[16:19], v9, s[8:9] offset:0 sc1
    global_load_dwordx4 v[20:23], v9, s[8:9] offset:512 sc1
    global_load_dwordx4 v[24:27], v9, s[8:9] offset:1024 sc1
    global_load_dwordx4 v[28:31], v9, s[8:9] offset:1536 sc1
L_DW3:
    s_waitcnt vmcnt(4)
    v_perm_b32 v224, v98, v96, s22
    v_perm_b32 v228, v98, v96, s23
    v_perm_b32 v232, v99, v97, s22
    v_perm_b32 v236, v99, v97, s23
    v_perm_b32 v225, v102, v100, s22
    v_perm_b32 v229, v102, v100, s23
    v_perm_b32 v233, v103, v101, s22
    v_perm_b32 v237, v103, v101, s23
    v_perm_b32 v226, v106, v104, s22
    v_perm_b32 v230, v106, v104, s23
    v_perm_b32 v234, v107, v105, s22
    v_perm_b32 v238, v107, v105, s23
    v_perm_b32 v227, v110, v108, s22
    v_perm_b32 v231, v110, v108, s23
    v_perm_b32 v235, v111, v109, s22
    v_perm_b32 v239, v111, v109, s23
    s_mov_b32 s21, 200000
    s_branch MPB_26
MSB_25:
    global_load_dwordx4 v[16:19], v9, s[8:9] offset:0 sc1
    global_load_dwordx4 v[20:23], v9, s[8:9] offset:512 sc1
    global_load_dwordx4 v[24:27], v9, s[8:9] offset:1024 sc1
    global_load_dwordx4 v[28:31], v9, s[8:9] offset:1536 sc1
MPB_26:
    s_waitcnt vmcnt(0)
    v_max3_u32 v2, v16, v17, v18
    v_max_u32 v2, v2, v19
    v_cmp_eq_u32 s[60:61], -1, v2
    v_max3_u32 v3, v20, v21, v22
    v_max_u32 v3, v3, v23
    v_cmp_eq_u32 s[62:63], -1, v3
    v_max3_u32 v2, v24, v25, v26
    v_max_u32 v2, v2, v27
    v_cmp_eq_u32 s[64:65], -1, v2
    v_max3_u32 v3, v28, v29, v30
    v_max_u32 v3, v3, v31
    v_cmp_eq_u32 s[66:67], -1, v3
    s_or_b64 s[78:79], s[60:61], s[62:63]
    s_or_b64 s[78:79], s[78:79], s[64:65]
    s_or_b64 s[78:79], s[78:79], s[66:67]
    s_cbranch_scc0 MDB_27
    s_bcnt1_i32_b64 s14, s[60:61]
    s_bcnt1_i32_b64 s15, s[62:63]
    s_add_u32 s14, s14, s15
    s_bcnt1_i32_b64 s15, s[64:65]
    s_add_u32 s14, s14, s15
    s_bcnt1_i32_b64 s15, s[66:67]
    s_add_u32 s14, s14, s15
    s_cmp_lt_u32 s14, 100
    s_cbranch_scc1 MN_29
    s_sleep 3
MN_29:
    s_mov_b64 exec, s[60:61]
    global_load_dwordx4 v[16:19], v9, s[8:9] offset:0 sc1
    s_mov_b64 exec, s[62:63]
    global_load_dwordx4 v[20:23], v9, s[8:9] offset:512 sc1
    s_mov_b64 exec, s[64:65]
    global_load_dwordx4 v[24:27], v9, s[8:9] offset:1024 sc1
    s_mov_b64 exec, s[66:67]
    global_load_dwordx4 v[28:31], v9, s[8:9] offset:1536 sc1
    s_mov_b64 exec, -1
    s_sub_u32 s21, s21, 1
    s_cbranch_scc0 MPB_26
    s_waitcnt vmcnt(0)
    s_branch MEB_28
MDB_27:
MEB_28:
L_DB1:
    v_mov_b32_dpp v36, v19 quad_perm:[0,1,0,1] row_mask:0xf bank_mask:0xf
    v_mov_b32_dpp v37, v23 quad_perm:[0,1,0,1] row_mask:0xf bank_mask:0xf
    v_mov_b32_dpp v38, v27 quad_perm:[0,1,0,1] row_mask:0xf bank_mask:0xf
    v_mov_b32_dpp v39, v31 quad_perm:[0,1,0,1] row_mask:0xf bank_mask:0xf
    v_max3_f32 v40, v36, v37, v38
    v_max_f32 v40, v40, v39
    v_perm_b32 v32, v17, v16, s30
    v_perm_b32 v33, v21, v20, s30
    v_max_f32_dpp v40, v40, v40 row_ror:4 row_mask:0xf bank_mask:0xf
    v_perm_b32 v34, v25, v24, s30
    v_perm_b32 v35, v29, v28, s30
    v_max_f32_dpp v40, v40, v40 row_ror:8 row_mask:0xf bank_mask:0xf
    v_mul_f32 v40, s35, v40
    v_fma_f32 v36, v36, s35, -v40
    v_fma_f32 v37, v37, s35, -v40
    v_fma_f32 v38, v38, s35, -v40
    v_fma_f32 v39, v39, s35, -v40
    v_exp_f32 v36, v36
    v_exp_f32 v37, v37
    v_exp_f32 v38, v38
    v_exp_f32 v39, v39
    v_lshl_or_b32 v32, v18, 24, v32
    v_lshl_or_b32 v33, v22, 24, v33
    v_lshl_or_b32 v34, v26, 24, v34
    v_lshl_or_b32 v35, v30, 24, v35
    v_mul_f32_dpp v60, v19, v36 quad_perm:[2,3,2,3] row_mask:0xf bank_mask:0xf
    v_pk_mul_f32 v[16:17], v[16:17], v[36:37] op_sel_hi:[1,0]
    v_mul_f32 v18, v18, v36
    v_mul_f32 v19, v32, v36
    v_fmac_f32_dpp v60, v23, v37 quad_perm:[2,3,2,3] row_mask:0xf bank_mask:0xf
    v_pk_fma_f32 v[16:17], v[20:21], v[36:37], v[16:17] op_sel:[0,1,0] op_sel_hi:[1,1,1]
    v_fmac_f32 v18, v22, v37
    v_fmac_f32 v19, v33, v37
    v_fmac_f32_dpp v60, v27, v38 quad_perm:[2,3,2,3] row_mask:0xf bank_mask:0xf
    v_pk_fma_f32 v[16:17], v[24:25], v[38:39], v[16:17] op_sel_hi:[1,0,1]
    v_fmac_f32 v18, v26, v38
    v_fmac_f32 v19, v34, v38
    v_fmac_f32_dpp v60, v31, v39 quad_perm:[2,3,2,3] row_mask:0xf bank_mask:0xf
    v_pk_fma_f32 v[16:17], v[28:29], v[38:39], v[16:17] op_sel:[0,1,0] op_sel_hi:[1,1,1]
    v_fmac_f32 v18, v30, v39
    v_fmac_f32 v19, v35, v39
    v_add_f32_dpp v60, v60, v60 row_ror:4 row_mask:0xf bank_mask:0xf
    v_add_f32_dpp v16, v16, v16 row_ror:4 row_mask:0xf bank_mask:0xf
    v_add_f32_dpp v17, v17, v17 row_ror:4 row_mask:0xf bank_mask:0xf
    v_add_f32_dpp v18, v18, v18 row_ror:4 row_mask:0xf bank_mask:0xf
    v_add_f32_dpp v19, v19, v19 row_ror:4 row_mask:0xf bank_mask:0xf
    v_add_f32_dpp v60, v60, v60 row_ror:8 row_mask:0xf bank_mask:0xf
    v_add_f32_dpp v16, v16, v16 row_ror:8 row_mask:0xf bank_mask:0xf
    v_add_f32_dpp v17, v17, v17 row_ror:8 row_mask:0xf bank_mask:0xf
    v_add_f32_dpp v18, v18, v18 row_ror:8 row_mask:0xf bank_mask:0xf
    v_add_f32_dpp v19, v19, v19 row_ror:8 row_mask:0xf bank_mask:0xf
    v_rcp_f32 v60, v60
    s_nop 0
    v_pk_mul_f32 v[16:17], v[16:17], v[60:61] op_sel_hi:[1,0]
    v_pk_mul_f32 v[18:19], v[18:19], v[60:61] op_sel_hi:[1,0]
    v_cvt_pk_bf16_f32 v20, v16, v17
    v_cvt_pk_bf16_f32 v21, v18, v19
    s_nop 0
    v_mov_b32_dpp v40, v20 quad_perm:[0,1,0,1] row_mask:0xf bank_mask:0xf
    v_mov_b32_dpp v41, v21 quad_perm:[0,1,0,1] row_mask:0xf bank_mask:0xf
    v_mov_b32_dpp v42, v20 quad_perm:[2,3,2,3] row_mask:0xf bank_mask:0xf
    v_mov_b32_dpp v43, v21 quad_perm:[2,3,2,3] row_mask:0xf bank_mask:0xf
    s_nop 1
    v_mfma_f32_16x16x32_bf16 v[44:47], v[40:43], v[224:227], 0
    v_mfma_f32_16x16x32_bf16 v[48:51], v[40:43], v[228:231], 0
    v_mfma_f32_16x16x32_bf16 v[52:55], v[40:43], v[232:235], 0
    v_mfma_f32_16x16x32_bf16 v[56:59], v[40:43], v[236:239], 0
    s_nop 5
    v_cndmask_b32 v44, v44, v48, s[84:85]
    v_cndmask_b32 v45, v45, v49, s[84:85]
    v_cndmask_b32 v44, v44, v52, s[86:87]
    v_cndmask_b32 v45, v45, v53, s[86:87]
    v_cndmask_b32 v44, v44, v56, s[88:89]
    v_cndmask_b32 v45, v45, v57, s[88:89]
    ds_write2_b32 v12, v44, v45 offset0:0 offset1:64
    s_cbranch_execz L_DB2
    s_waitcnt lgkmcnt(0)
    s_barrier
    s_cmp_lg_u32 s18, 0
    s_cbranch_scc1 L_BX
L_DB2:
    s_mov_b32 exec_hi, 0
    ds_read_b128 v[16:19], v13 offset:11776
    ds_read_b128 v[20:23], v13 offset:12288
    ds_read_b128 v[24:27], v13 offset:12800
    ds_read_b128 v[28:31], v13 offset:13312
    s_waitcnt lgkmcnt(2)
    v_pk_add_f32 v[16:17], v[16:17], v[20:21]
    v_pk_add_f32 v[18:19], v[18:19], v[22:23]
    s_waitcnt lgkmcnt(0)
    v_pk_add_f32 v[24:25], v[24:25], v[28:29]
    v_pk_add_f32 v[26:27], v[26:27], v[30:31]
    v_pk_add_f32 v[16:17], v[16:17], v[24:25]
    v_pk_add_f32 v[18:19], v[18:19], v[26:27]
    s_cbranch_execz L_DMR
    global_store_dwordx4 v11, v[16:19], s[8:9] sc1
    s_mov_b32 exec_hi, -1
    s_branch L_CP
L_BX:
    s_cmp_lt_u32 s76, 192
    s_cbranch_scc1 L_CP
    s_cmp_ge_u32 s3, 6
    s_cbranch_scc1 L_CP
    s_sub_u32 s14, s76, 192
    s_cmp_ge_u32 s14, 32
    s_cbranch_scc1 L_FIN
    v_mov_b32 v44, -1
    v_mov_b32 v45, -1
    v_mov_b32 v46, -1
    v_mov_b32 v47, -1
    global_store_dwordx4 v202, v[44:47], s[8:9] offset:0 sc1
    global_store_dwordx4 v202, v[44:47], s[8:9] offset:1024 sc1
    global_store_dwordx4 v202, v[44:47], s[8:9] offset:2048 sc1
    global_store_dwordx4 v202, v[44:47], s[8:9] offset:3072 sc1
    global_store_dwordx4 v203, v[44:47], s[8:9] offset:0 sc1
    global_store_dwordx4 v203, v[44:47], s[8:9] offset:1024 sc1
    global_store_dwordx4 v203, v[44:47], s[8:9] offset:2048 sc1
    s_mov_b32 s21, 200000
MQR_34:
    global_load_dwordx4 v[16:19], v200, s[8:9] offset:0 sc1
    s_waitcnt vmcnt(0)
    v_cmp_ne_u32 vcc, -1, v19
    s_nop 0
    s_cbranch_vccnz MSR_30
    s_sleep 4
    s_sub_u32 s21, s21, 1
    s_cbranch_scc0 MQR_34
MSR_30:
    global_load_dwordx4 v[16:19], v200, s[8:9] offset:0 sc1
    global_load_dwordx4 v[20:23], v200, s[8:9] offset:1024 sc1
    global_load_dwordx4 v[24:27], v200, s[8:9] offset:2048 sc1
    global_load_dwordx4 v[28:31], v200, s[8:9] offset:3072 sc1
MPR_31:
L_DMR:
    s_waitcnt vmcnt(0)
    v_max3_u32 v2, v16, v17, v18
    v_max_u32 v2, v2, v19
    v_cmp_eq_u32 s[60:61], -1, v2
    v_max3_u32 v3, v20, v21, v22
    v_max_u32 v3, v3, v23
    v_cmp_eq_u32 s[62:63], -1, v3
    v_max3_u32 v2, v24, v25, v26
    v_max_u32 v2, v2, v27
    v_cmp_eq_u32 s[64:65], -1, v2
    v_max3_u32 v3, v28, v29, v30
    v_max_u32 v3, v3, v31
    v_cmp_eq_u32 s[66:67], -1, v3
    s_or_b64 s[78:79], s[60:61], s[62:63]
    s_or_b64 s[78:79], s[78:79], s[64:65]
    s_or_b64 s[78:79], s[78:79], s[66:67]
    s_cbranch_scc0 MDR_32
    s_mov_b64 exec, s[60:61]
    global_load_dwordx4 v[16:19], v200, s[8:9] offset:0 sc1
    s_mov_b64 exec, s[62:63]
    global_load_dwordx4 v[20:23], v200, s[8:9] offset:1024 sc1
    s_mov_b64 exec, s[64:65]
    global_load_dwordx4 v[24:27], v200, s[8:9] offset:2048 sc1
    s_mov_b64 exec, s[66:67]
    global_load_dwordx4 v[28:31], v200, s[8:9] offset:3072 sc1
    s_mov_b64 exec, -1
    s_sub_u32 s21, s21, 1
    s_cbranch_scc0 MPR_31
    s_waitcnt vmcnt(0)
    s_branch MER_33
MDR_32:
MER_33:
    v_pk_add_f32 v[16:17], v[16:17], v[20:21]
    v_pk_add_f32 v[18:19], v[18:19], v[22:23]
    v_pk_add_f32 v[24:25], v[24:25], v[28:29]
    v_pk_add_f32 v[26:27], v[26:27], v[30:31]
    v_pk_add_f32 v[16:17], v[16:17], v[24:25]
    v_pk_add_f32 v[18:19], v[18:19], v[26:27]
    s_nop 0
    v_permlane32_swap_b32 v16, v17
    v_permlane32_swap_b32 v18, v19
    v_add_f32 v16, v16, v17
    v_add_f32 v18, v18, v19
    s_nop 1
    v_permlane16_swap_b32 v16, v18
    v_add_f32 v16, v16, v18
    s_nop 1
    v_add_f32_dpp v16, v16, v16 row_ror:8 row_mask:0xf bank_mask:0xf
    v_cvt_pk_bf16_f32 v16, v16, v16
    v_and_b32 v16, 0xffff0000, v16
    v_mul_f32 v16, v16, v208
    v_cvt_pk_bf16_f32 v16, v16, v16
    v_and_b32 v16, 0xffff0000, v16
    v_add_f32 v16, v16, v210
    v_mov_b32 v17, v16
    v_mov_b32 v18, v16
    s_nop 1
    v_permlane32_swap_b32 v17, v18
    v_cvt_pk_bf16_f32 v206, v17, v18
    s_cbranch_execz L_DMF
    global_store_dwordx2 v201, v[206:207], s[8:9] sc1
    global_store_dwordx2 v205, v[206:207], s[8:9] sc1
    v_cvt_pk_bf16_f32 v212, v16, v16
    v_and_b32 v212, 0xffff0000, v212
    s_sleep 40
    s_mov_b32 s21, 200000
MQF_39:
    global_load_dwordx4 v[16:19], v202, s[8:9] offset:0 sc1
    s_waitcnt vmcnt(0)
    v_cmp_ne_u32 vcc, -1, v19
    s_nop 0
    s_cbranch_vccnz MSF_35
    s_sleep 4
    s_sub_u32 s21, s21, 1
    s_cbranch_scc0 MQF_39
MSF_35:
    global_load_dwordx4 v[16:19], v202, s[8:9] offset:0 sc1
    global_load_dwordx4 v[20:23], v202, s[8:9] offset:1024 sc1
    global_load_dwordx4 v[24:27], v202, s[8:9] offset:2048 sc1
    global_load_dwordx4 v[28:31], v202, s[8:9] offset:3072 sc1
    global_load_dwordx4 v[32:35], v203, s[8:9] offset:0 sc1
    global_load_dwordx4 v[36:39], v203, s[8:9] offset:1024 sc1
    global_load_dwordx4 v[40:43], v203, s[8:9] offset:2048 sc1
MPF_36:
L_DMF:
    s_waitcnt vmcnt(0)
    v_max3_u32 v2, v16, v17, v18
    v_max_u32 v2, v2, v19
    v_cmp_eq_u32 s[60:61], -1, v2
    v_max3_u32 v3, v20, v21, v22
    v_max_u32 v3, v3, v23
    v_cmp_eq_u32 s[62:63], -1, v3
    v_max3_u32 v2, v24, v25, v26
    v_max_u32 v2, v2, v27
    v_cmp_eq_u32 s[64:65], -1, v2
    v_max3_u32 v3, v28, v29, v30
    v_max_u32 v3, v3, v31
    v_cmp_eq_u32 s[66:67], -1, v3
    v_max3_u32 v2, v32, v33, v34
    v_max_u32 v2, v2, v35
    v_cmp_eq_u32 s[68:69], -1, v2
    v_max3_u32 v3, v36, v37, v38
    v_max_u32 v3, v3, v39
    v_cmp_eq_u32 s[70:71], -1, v3
    v_max3_u32 v2, v40, v41, v42
    v_max_u32 v2, v2, v43
    v_cmp_eq_u32 s[72:73], -1, v2
    s_or_b64 s[78:79], s[60:61], s[62:63]
    s_or_b64 s[78:79], s[78:79], s[64:65]
    s_or_b64 s[78:79], s[78:79], s[66:67]
    s_or_b64 s[78:79], s[78:79], s[68:69]
    s_or_b64 s[78:79], s[78:79], s[70:71]
    s_or_b64 s[78:79], s[78:79], s[72:73]
    s_cbranch_scc0 MDF_37
    s_mov_b64 exec, s[60:61]
    global_load_dwordx4 v[16:19], v202, s[8:9] offset:0 sc1
    s_mov_b64 exec, s[62:63]
    global_load_dwordx4 v[20:23], v202, s[8:9] offset:1024 sc1
    s_mov_b64 exec, s[64:65]
    global_load_dwordx4 v[24:27], v202, s[8:9] offset:2048 sc1
    s_mov_b64 exec, s[66:67]
    global_load_dwordx4 v[28:31], v202, s[8:9] offset:3072 sc1
    s_mov_b64 exec, s[68:69]
    global_load_dwordx4 v[32:35], v203, s[8:9] offset:0 sc1
    s_mov_b64 exec, s[70:71]
    global_load_dwordx4 v[36:39], v203, s[8:9] offset:1024 sc1
    s_mov_b64 exec, s[72:73]
    global_load_dwordx4 v[40:43], v203, s[8:9] offset:2048 sc1
    s_mov_b64 exec, -1
    s_sub_u32 s21, s21, 1
    s_cbranch_scc0 MPF_36
    s_waitcnt vmcnt(0)
    s_branch MEF_38
MDF_37:
MEF_38:
    v_pk_add_f32 v[16:17], v[16:17], v[20:21]
    v_pk_add_f32 v[18:19], v[18:19], v[22:23]
    v_pk_add_f32 v[24:25], v[24:25], v[28:29]
    v_pk_add_f32 v[26:27], v[26:27], v[30:31]
    v_pk_add_f32 v[32:33], v[32:33], v[36:37]
    v_pk_add_f32 v[34:35], v[34:35], v[38:39]
    v_pk_add_f32 v[16:17], v[16:17], v[24:25]
    v_pk_add_f32 v[18:19], v[18:19], v[26:27]
    v_pk_add_f32 v[32:33], v[32:33], v[40:41]
    v_pk_add_f32 v[34:35], v[34:35], v[42:43]
    v_pk_add_f32 v[16:17], v[16:17], v[32:33]
    v_pk_add_f32 v[18:19], v[18:19], v[34:35]
    s_nop 0
    v_permlane32_swap_b32 v16, v17
    v_permlane32_swap_b32 v18, v19
    v_add_f32 v16, v16, v17
    v_add_f32 v18, v18, v19
    s_nop 1
    v_permlane16_swap_b32 v16, v18
    v_add_f32 v16, v16, v18
    s_nop 1
    v_add_f32_dpp v16, v16, v16 row_ror:8 row_mask:0xf bank_mask:0xf
    v_cvt_pk_bf16_f32 v16, v16, v16
    v_and_b32 v16, 0xffff0000, v16
    v_mul_f32 v16, v16, v209
    v_cvt_pk_bf16_f32 v16, v16, v16
    v_and_b32 v16, 0xffff0000, v16
    v_add_f32 v16, v16, v212
    v_cvt_pk_bf16_f32 v16, v16, v16
    s_cbranch_execz L_DL1
    s_mov_b64 exec, s[42:43]
    global_store_short v204, v16, s[58:59]
    s_mov_b64 exec, 1
    s_cmp_lg_u32 s13, 0
    s_cbranch_scc1 L_NOEP
    global_store_dword v4, v213, s[8:9] sc0 sc1
L_NOEP:
    s_mov_b64 exec, -1
    s_branch L_FIN
L_CP:
    s_bfe_u32 s14, s76, 0x20004
    s_lshl_b32 s13, s14, 4
    s_and_b32 s14, s76, 7
    s_lshl_b32 s14, s14, 1
    s_add_u32 s13, s13, s14
    s_bfe_u32 s14, s76, 0x10003
    s_add_u32 s13, s13, s14
    s_lshr_b32 s14, s76, 6
    s_cmp_eq_u32 s14, 2
    s_cselect_b32 s13, s13, 99
    s_cmp_ge_u32 s13, 56
    s_cbranch_scc1 L_FIN
    s_and_b32 s14, s3, 1
    s_mul_i32 s15, s14, 64
    s_and_b32 s16, s76, 1
    s_lshl_b32 s16, s16, 12
    s_add_u32 s15, s15, s16
    s_and_b32 s16, s76, 2
    s_lshl_b32 s16, s16, 13
    s_add_u32 s15, s15, s16
    s_and_b32 s16, s76, 4
    s_lshl_b32 s16, s16, 11
    s_add_u32 s15, s15, s16
    s_add_u32 s15, s15, 131072
    s_xor_b32 s15, s15, s92
    v_lshrrev_b32 v9, 2, v0
    v_lshlrev_b32 v9, 7, v9
    v_and_b32 v10, 48, v5
    v_add3_u32 v9, v9, v10, s15
    s_lshl_b32 s14, s14, 10
    v_lshlrev_b32 v10, 3, v0
    v_add_u32 v10, s14, v10
    s_mov_b32 s33, 0x3b000000
    s_and_b32 s14, s3, 2
    s_lshl_b32 s15, s14, 8
    v_add_u32 v10, s15, v10
    s_lshl_b32 s15, s14, 10
    v_add_u32 v9, s15, v9
    v_xor_b32 v11, 0x800, v9
    s_sleep 40
    s_mov_b32 s21, 200000
    global_load_dwordx4 v[16:19], v9, s[8:9] sc1
    global_load_dwordx4 v[20:23], v11, s[8:9] sc1
KPC_40:
    s_waitcnt vmcnt(0)
    v_xor_b32 v2, s20, v17
    v_bitop3_b32 v2, v2, v19, s20 bitop3:0xf6
    v_cmp_ne_u32 s[60:61], 0, v2
    v_xor_b32 v3, s20, v21
    v_bitop3_b32 v3, v3, v23, s20 bitop3:0xf6
    v_cmp_ne_u32 s[62:63], 0, v3
    s_nop 0
    s_or_b64 s[78:79], s[60:61], s[62:63]
    s_cbranch_scc0 KEC_41
    s_mov_b64 exec, s[60:61]
    global_load_dwordx4 v[16:19], v9, s[8:9] sc1
    s_mov_b64 exec, s[62:63]
    global_load_dwordx4 v[20:23], v11, s[8:9] sc1
    s_mov_b64 exec, -1
    s_sub_u32 s21, s21, 1
    s_cbranch_scc0 KPC_40
    s_waitcnt vmcnt(0)
KEC_41:
L_DL1:
    v_lshlrev_b32 v32, 16, v16
    v_and_b32 v33, 0xffff0000, v16
    v_lshlrev_b32 v34, 16, v18
    v_and_b32 v35, 0xffff0000, v18
    v_lshlrev_b32 v36, 16, v20
    v_and_b32 v37, 0xffff0000, v20
    v_lshlrev_b32 v38, 16, v22
    v_and_b32 v39, 0xffff0000, v22
    v_readfirstlane_b32 s30, v32
    s_nop 1
    v_pk_add_f32 v[42:43], v[32:33], s[30:31] op_sel_hi:[1,0] neg_lo:[0,1] neg_hi:[0,1]
    v_pk_add_f32 v[44:45], v[34:35], s[30:31] op_sel_hi:[1,0] neg_lo:[0,1] neg_hi:[0,1]
    v_pk_add_f32 v[46:47], v[36:37], s[30:31] op_sel_hi:[1,0] neg_lo:[0,1] neg_hi:[0,1]
    v_pk_add_f32 v[48:49], v[38:39], s[30:31] op_sel_hi:[1,0] neg_lo:[0,1] neg_hi:[0,1]
    v_pk_add_f32 v[50:51], v[42:43], v[44:45]
    v_pk_mul_f32 v[40:41], v[42:43], v[42:43]
    v_pk_add_f32 v[56:57], v[46:47], v[48:49]
    v_pk_fma_f32 v[40:41], v[44:45], v[44:45], v[40:41]
    v_pk_fma_f32 v[40:41], v[46:47], v[46:47], v[40:41]
    v_pk_fma_f32 v[40:41], v[48:49], v[48:49], v[40:41]
    v_pk_add_f32 v[50:51], v[50:51], v[56:57]
    v_add_f32 v41, v40, v41
    v_add_f32 v40, v50, v51
    s_nop 0
    v_add_f32_dpp v41, v41, v41 quad_perm:[1,0,3,2] row_mask:0xf bank_mask:0xf
    v_add_f32_dpp v40, v40, v40 quad_perm:[1,0,3,2] row_mask:0xf bank_mask:0xf
    s_nop 0
    v_add_f32_dpp v41, v41, v41 quad_perm:[2,3,0,1] row_mask:0xf bank_mask:0xf
    v_add_f32_dpp v40, v40, v40 quad_perm:[2,3,0,1] row_mask:0xf bank_mask:0xf
    s_nop 0
    v_add_f32_dpp v41, v41, v41 row_half_mirror row_mask:0xf bank_mask:0xf
    v_add_f32_dpp v40, v40, v40 row_half_mirror row_mask:0xf bank_mask:0xf
    s_nop 0
    v_add_f32_dpp v41, v41, v41 row_mirror row_mask:0xf bank_mask:0xf
    v_add_f32_dpp v40, v40, v40 row_mirror row_mask:0xf bank_mask:0xf
    s_nop 1
    v_permlane16_swap_b32 v40, v41
    v_add_f32 v40, v40, v41
    v_mov_b32 v41, v40
    s_nop 1
    v_permlane32_swap_b32 v40, v41
    v_add_f32 v40, v40, v41
    v_mul_f32 v42, s33, v40
    v_mul_f32 v43, s33, v40
    s_nop 1
    v_permlane16_swap_b32 v42, v43
    v_add_f32 v40, s30, v42
    v_fma_f32 v41, -v42, v42, v43
    v_max_f32 v41, 0, v41
    v_cvt_pk_bf16_f32 v42, v40, v41
    v_and_b32 v41, 0xffff0000, v42
    v_lshlrev_b32 v40, 16, v42
    v_add_f32 v41, 0x3727c5ac, v41
    v_pk_add_f32 v[32:33], v[32:33], v[40:41] op_sel_hi:[1,0] neg_lo:[0,1] neg_hi:[0,1]
    v_pk_add_f32 v[34:35], v[34:35], v[40:41] op_sel_hi:[1,0] neg_lo:[0,1] neg_hi:[0,1]
    v_cvt_pk_bf16_f32 v41, v41, v41
    v_and_b32 v41, 0xffff0000, v41
    v_sqrt_f32 v41, v41
    v_cvt_pk_bf16_f32 v44, v32, v33
    v_cvt_pk_bf16_f32 v45, v34, v35
    v_cvt_pk_bf16_f32 v50, v41, v41
    v_and_b32 v50, 0xffff0000, v50
    v_rcp_f32 v41, v50
    v_lshlrev_b32 v32, 16, v44
    v_and_b32 v33, 0xffff0000, v44
    v_lshlrev_b32 v34, 16, v45
    v_and_b32 v35, 0xffff0000, v45
    v_pk_mul_f32 v[32:33], v[32:33], v[40:41] op_sel:[0,1] op_sel_hi:[1,1]
    v_pk_mul_f32 v[34:35], v[34:35], v[40:41] op_sel:[0,1] op_sel_hi:[1,1]
    v_cvt_pk_bf16_f32 v44, v32, v33
    v_lshlrev_b32 v32, 16, v44
    v_and_b32 v33, 0xffff0000, v44
    v_cvt_pk_bf16_f32 v45, v34, v35
    v_lshlrev_b32 v34, 16, v45
    v_and_b32 v35, 0xffff0000, v45
    v_pk_mul_f32 v[32:33], v[32:33], v[216:217]
    v_pk_mul_f32 v[34:35], v[34:35], v[218:219]
    v_cvt_pk_bf16_f32 v44, v32, v33
    v_lshlrev_b32 v32, 16, v44
    v_and_b32 v33, 0xffff0000, v44
    v_cvt_pk_bf16_f32 v45, v34, v35
    v_lshlrev_b32 v34, 16, v45
    v_and_b32 v35, 0xffff0000, v45
    v_pk_add_f32 v[32:33], v[32:33], v[208:209]
    v_pk_add_f32 v[34:35], v[34:35], v[210:211]
    v_cvt_pk_bf16_f32 v52, v32, v33
    v_cvt_pk_bf16_f32 v53, v34, v35
    ds_write_b64 v10, v[52:53] offset:1312
    s_cbranch_execz L_DS2
    s_waitcnt lgkmcnt(0)
    s_barrier
    s_branch L_FIN
.section .rodata,"a"
.p2align 6
.amdhsa_kernel adaLN_cond__gqa_block_cached__glu_gated_geglu__decode_kernel
  .amdhsa_next_free_vgpr 256
  .amdhsa_next_free_sgpr 102
  .amdhsa_accum_offset 256
  .amdhsa_group_segment_fixed_size 0
  .amdhsa_kernarg_size 112
  .amdhsa_user_sgpr_count 2
  .amdhsa_user_sgpr_kernarg_segment_ptr 1
  .amdhsa_system_sgpr_workgroup_id_x 1
  .amdhsa_float_denorm_mode_32 3
.end_amdhsa_kernel
```
